```python
import torch

def _softmax(x, axis=-1):
    return torch.softmax(x, dim=axis)
def _gelu(x):
    return torch.nn.functional.gelu(x, approximate="tanh")
def _silu(x):
    return torch.nn.functional.silu(x)
def _sigmoid(x):
    return torch.sigmoid(x)
def _layernorm(x, axis=-1, eps=1e-5):
    m = x.mean(dim=axis, keepdim=True)
    v = x.var(dim=axis, keepdim=True, unbiased=False)
    return (x - m) / torch.sqrt(v + eps)
def _scatter_add(tgt, idx, src, axis=0):
    return tgt.clone().index_add_(axis, idx, src)
def _segment_sum(src, seg, n):
    out = torch.zeros((n,) + src.shape[1:], dtype=src.dtype)
    return out.index_add_(0, seg, src)
def _pad(x, pw):
    flat = tuple(v for pair in reversed(pw) for v in pair)
    return torch.nn.functional.pad(x, flat)

kernel_name = 'interleave_layers__spectral_fnet__moe_arch_mod__prompt'

def setup_inputs():

    _w = (lambda a: (lambda t: t.to(torch.bfloat16) if t.is_floating_point() else t)(torch.as_tensor(a)))
    def _A_setup():
        B, S, D = 1, 2048, 640
        ns = torch.arange(S)[:, None] * torch.arange(S)[None, :]
        nd = torch.arange(D)[:, None] * torch.arange(D)[None, :]
        Ws_re = torch.cos(-2.0 * torch.pi * ns / S).to(float)
        Ws_im = torch.sin(-2.0 * torch.pi * ns / S).to(float)
        Wd_re = torch.cos(-2.0 * torch.pi * nd / D).to(float)
        Wd_im = torch.sin(-2.0 * torch.pi * nd / D).to(float)
        return {
            "x": _w((lambda *s: torch.randn(*s, dtype=torch.bfloat16) * 0.1)(B, S, D)),
            "dft_seq_re": _w(Ws_re),
            "dft_seq_im": _w(Ws_im),
            "dft_hid_re": _w(Wd_re),
            "dft_hid_im": _w(Wd_im),
        }
    _A_in = _A_setup()

    def _B_setup():
        B, S, D, F, C = 1, 2048, 640, 1728, 8
        return {
            "x": _w((lambda *s: torch.randn(*s, dtype=torch.bfloat16) * 0.1)(B, S, D)),
            "w_r": _w((lambda *s: torch.randn(*s, dtype=torch.bfloat16) * 1.6)(D)),
            "w_gate": _w((lambda *s: torch.randn(*s, dtype=torch.bfloat16) * 0.4)(D, F)),
            "w_up": _w((lambda *s: torch.randn(*s, dtype=torch.bfloat16) * 0.4)(D, F)),
            "w_down": _w((lambda *s: torch.randn(*s, dtype=torch.bfloat16) * 0.4)(F, D)),
        }
    _B_in = _B_setup()

    return {
        "A_x": _A_in["x"],
        "A_dft_seq_re": _A_in["dft_seq_re"],
        "A_dft_seq_im": _A_in["dft_seq_im"],
        "A_dft_hid_re": _A_in["dft_hid_re"],
        "A_dft_hid_im": _A_in["dft_hid_im"],
        "B_x": _B_in["x"],
        "B_w_r": _B_in["w_r"],
        "B_w_gate": _B_in["w_gate"],
        "B_w_up": _B_in["w_up"],
        "B_w_down": _B_in["w_down"],
    }

def reference(A_x, A_dft_seq_re, A_dft_seq_im, A_dft_hid_re, A_dft_hid_im, B_x, B_w_r, B_w_gate, B_w_up, B_w_down):
    def _A_ref(x, dft_seq_re, dft_seq_im, dft_hid_re, dft_hid_im):
        a = torch.einsum("bsd,ed->bse", x, dft_hid_re)
        b = torch.einsum("bsd,ed->bse", x, dft_hid_im)
        y = torch.einsum("ts,bse->bte", dft_seq_re, a) - torch.einsum("ts,bse->bte", dft_seq_im, b)
        return y

    def _B_ref(x, w_r, w_gate, w_up, w_down):
        B, S, D = x.shape
        C = 8
        r = x @ w_r
        idx = torch.argsort(-r, axis=-1)[:, :C]
        idx_e = (lambda x, n, axis: torch.repeat_interleave(x, n, dim=axis))(idx.reshape(B, C, 1), D, axis=2)
        x_sel = (lambda x, i, axis: torch.take_along_dim(x, i, dim=axis))(x, idx_e, axis=1)
        g = _silu(x_sel @ w_gate)
        u = x_sel @ w_up
        y = (g * u) @ w_down
        r_sel = _sigmoid((lambda x, i, axis: torch.take_along_dim(x, i, dim=axis))(r, idx, axis=1))
        y = y * r_sel.reshape(B, C, 1)
        b_off = (torch.arange(B) * S).reshape(B, 1)
        flat_idx = (idx + b_off).reshape(B * C)
        zero = (x * 0.0).reshape(B * S, D)
        upd = _scatter_add(zero, flat_idx, y.reshape(B * C, D), axis=0)
        return x + upd.reshape(B, S, D)

    x = A_x
    x = x + _A_ref(_layernorm(x, axis=-1), A_dft_seq_re, A_dft_seq_im, A_dft_hid_re, A_dft_hid_im)
    x = x + _B_ref(_layernorm(x, axis=-1), B_w_r, B_w_gate, B_w_up, B_w_down)
    x = x + _A_ref(_layernorm(x, axis=-1), A_dft_seq_re, A_dft_seq_im, A_dft_hid_re, A_dft_hid_im)
    x = x + _B_ref(_layernorm(x, axis=-1), B_w_r, B_w_gate, B_w_up, B_w_down)
    return x
```

```asm
; @launch grid=(491,1,1) block=(256,1,1) lds=53248
.amdgcn_target "amdgcn-amd-amdhsa--gfx950"
.text
.set CODE_LINES, 256
.set CODE_LINES2, 2
.globl interleave_layers__spectral_fnet__moe_arch_mod__prompt_kernel
.p2align 8
.type interleave_layers__spectral_fnet__moe_arch_mod__prompt_kernel,@function
interleave_layers__spectral_fnet__moe_arch_mod__prompt_kernel:
    s_cmp_ge_u32 s2, 491
    s_cbranch_scc1 L_end
    s_load_dwordx2 s[40:41], s[0:1], 96
    s_load_dwordx2 s[42:43], s[0:1], 0
    s_load_dwordx4 s[44:47], s[0:1], 48
    s_load_dwordx4 s[48:51], s[0:1], 64
    s_load_dwordx4 s[52:55], s[0:1], 80
    s_getpc_b64 s[60:61]
    s_and_b32 s60, s60, -256
    v_lshlrev_b32 v2, 7, v0
    v_mov_b32 v3, s61
    v_add_co_u32 v2, vcc, s60, v2
    s_nop 1
    v_addc_co_u32 v3, vcc, 0, v3, vcc
    v_cmp_gt_u32 vcc, CODE_LINES, v0
    s_nop 0
    s_and_saveexec_b64 s[62:63], vcc
    s_nop 2
    s_cbranch_execz L_nopf
    global_load_dword v255, v[2:3], off
    v_add_co_u32 v2, vcc, 0x8000, v2
    s_nop 1
    v_addc_co_u32 v3, vcc, 0, v3, vcc
    v_cmp_gt_u32 vcc, CODE_LINES2, v0
    s_nop 0
    s_and_b64 exec, exec, vcc
    s_nop 2
    s_cbranch_execz L_nopf
    global_load_dword v255, v[2:3], off
L_nopf:
    s_mov_b64 exec, s[62:63]
    v_lshrrev_b32 v2, 6, v0
    v_and_b32 v1, 63, v0
    v_readfirstlane_b32 s21, v2
    s_waitcnt lgkmcnt(0)
    s_mov_b32 s4, s40
    s_and_b32 s5, s41, 0xffff
    s_mov_b32 s6, 22020096
    s_mov_b32 s7, 0x00020000
    s_cmp_lt_u32 s2, 256
    s_cbranch_scc1 L_roleR
    s_cmp_lt_u32 s2, 417
    s_cbranch_scc1 L_roleC
    s_cmp_lt_u32 s2, 471
    s_cbranch_scc1 L_roleFa
    s_branch L_roleFb
L_roleR:
    s_setprio 2
    s_mov_b32 s8, s42
    s_and_b32 s9, s43, 0xffff
    s_mov_b32 s10, 2621440
    s_mov_b32 s11, 0x00020000
    s_and_b32 s60, s2, 7
    s_lshr_b32 s61, s2, 3
    s_lshr_b32 s23, s61, 3
    s_and_b32 s61, s61, 7
    s_lshl_b32 s60, s60, 3
    s_sub_u32 s62, 56, s60
    s_cmp_lt_u32 s23, 2
    s_cselect_b32 s60, s60, s62
    s_add_u32 s24, s60, s61
    s_lshl_b32 s60, s23, 9
    s_lshl_b32 s61, s21, 7
    s_add_u32 s25, s60, s61
    s_add_u32 s25, s25, s24
    s_mul_i32 s28, s25, 1280
    s_add_u32 s63, s28, 81920
    v_and_b32 v160, 31, v1
    v_lshrrev_b32 v161, 5, v1
    v_mul_u32_u24 v2, 640, v161
    v_lshl_add_u32 v2, v160, 1, v2
    v_mov_b32 v116, 0
    v_mov_b32 v117, 0
    buffer_load_short_d16_hi v116, v2, s[8:11], s28 offen offset:0
    buffer_load_short_d16_hi v117, v2, s[8:11], s63 offen offset:0
    v_mov_b32 v118, 0
    v_mov_b32 v119, 0
    buffer_load_short_d16_hi v118, v2, s[8:11], s28 offen offset:64
    buffer_load_short_d16_hi v119, v2, s[8:11], s63 offen offset:64
    v_mov_b32 v120, 0
    v_mov_b32 v121, 0
    buffer_load_short_d16_hi v120, v2, s[8:11], s28 offen offset:128
    buffer_load_short_d16_hi v121, v2, s[8:11], s63 offen offset:128
    v_mov_b32 v122, 0
    v_mov_b32 v123, 0
    buffer_load_short_d16_hi v122, v2, s[8:11], s28 offen offset:192
    buffer_load_short_d16_hi v123, v2, s[8:11], s63 offen offset:192
    v_mov_b32 v124, 0
    v_mov_b32 v125, 0
    buffer_load_short_d16_hi v124, v2, s[8:11], s28 offen offset:256
    buffer_load_short_d16_hi v125, v2, s[8:11], s63 offen offset:256
    v_mov_b32 v126, 0
    v_mov_b32 v127, 0
    buffer_load_short_d16_hi v126, v2, s[8:11], s28 offen offset:320
    buffer_load_short_d16_hi v127, v2, s[8:11], s63 offen offset:320
    v_mov_b32 v128, 0
    v_mov_b32 v129, 0
    buffer_load_short_d16_hi v128, v2, s[8:11], s28 offen offset:384
    buffer_load_short_d16_hi v129, v2, s[8:11], s63 offen offset:384
    v_mov_b32 v130, 0
    v_mov_b32 v131, 0
    buffer_load_short_d16_hi v130, v2, s[8:11], s28 offen offset:448
    buffer_load_short_d16_hi v131, v2, s[8:11], s63 offen offset:448
    v_mov_b32 v132, 0
    v_mov_b32 v133, 0
    buffer_load_short_d16_hi v132, v2, s[8:11], s28 offen offset:512
    buffer_load_short_d16_hi v133, v2, s[8:11], s63 offen offset:512
    v_mov_b32 v134, 0
    v_mov_b32 v135, 0
    buffer_load_short_d16_hi v134, v2, s[8:11], s28 offen offset:576
    buffer_load_short_d16_hi v135, v2, s[8:11], s63 offen offset:576
    v_mov_b32 v136, 0
    buffer_load_dword v136, v136, s[4:7], 0 offen
    s_lshl_b32 s22, s23, 6
    s_add_u32 s22, s22, s24
    s_mul_i32 s29, s22, 10368
    v_mov_b32 v140, -1
    v_mov_b32 v141, -1
    v_mov_b32 v142, -1
    v_mov_b32 v143, -1
    v_lshlrev_b32 v14, 4, v0
    v_add_u32 v115, 4208, v14
    v_add_u32 v162, 4096, v14
    v_cmp_gt_u32 vcc, 65, v0
    s_nop 1
    v_cndmask_b32 v115, v115, v162, vcc
    v_lshlrev_b32 v164, 3, v0
    s_lshl_b32 s61, s22, 11
    s_add_u32 s61, s61, 458752
    buffer_store_dwordx2 v[140:141], v164, s[4:7], s61 offen sc1
    s_add_u32 s60, s29, 1048576
    s_add_u32 s62, s60, 8304
    buffer_store_dwordx4 v[140:143], v14, s[4:7], s60 offen sc1
    buffer_store_dwordx4 v[140:143], v115, s[4:7], s60 offen sc1
    s_cmp_ge_u32 s21, 2
    s_nop 0
    s_cbranch_scc1 Lw2_1
    buffer_store_dwordx4 v[140:143], v14, s[4:7], s62 offen sc1
    s_nop 1
Lw2_1:
    v_bfe_u32 v166, v160, 2, 1
    v_mul_u32_u24 v166, 10, v166
    v_and_b32 v169, 3, v160
    v_add_u32 v166, v166, v169
    v_lshrrev_b32 v169, 3, v160
    v_lshl_add_u32 v166, v169, 2, v166
    v_cvt_f32_u32 v166, v166
    v_cvt_f32_u32 v172, v161
    v_cvt_f32_u32 v173, s21
    s_lshl_b32 s60, s21, 10
    s_add_u32 s60, s60, 24576
    v_lshl_add_u32 v174, v1, 4, s60
    v_mul_f32 v167, 0x3d4ccccd, v166
    v_mul_f32 v168, 0x41200000, v172
    v_fma_f32 v168, 4.0, v173, v168
    v_mul_f32 v168, v167, v168
    s_cmp_lt_u32 s21, 2
    s_cselect_b64 s[64:65], -1, 0
    v_fmamk_f32 v169, v167, 0x00000000, v168
    v_cos_f32 v170, v169
    v_sin_f32 v171, v169
    s_nop 0
    v_cvt_pk_f16_f32 v176, v170, v171
    v_cvt_pk_f16_f32 v180, -v171, v170
    v_fmamk_f32 v169, v167, 0x3f800000, v168
    v_cos_f32 v170, v169
    v_sin_f32 v171, v169
    s_nop 0
    v_cvt_pk_f16_f32 v177, v170, v171
    v_cvt_pk_f16_f32 v181, -v171, v170
    v_fmamk_f32 v169, v167, 0x40000000, v168
    v_cos_f32 v170, v169
    v_sin_f32 v171, v169
    s_nop 0
    v_cvt_pk_f16_f32 v178, v170, v171
    v_cvt_pk_f16_f32 v182, -v171, v170
    v_cndmask_b32 v178, 0, v178, s[64:65]
    v_cndmask_b32 v182, 0, v182, s[64:65]
    v_fmamk_f32 v169, v167, 0x40400000, v168
    v_cos_f32 v170, v169
    v_sin_f32 v171, v169
    s_nop 0
    v_cvt_pk_f16_f32 v179, v170, v171
    v_cvt_pk_f16_f32 v183, -v171, v170
    v_cndmask_b32 v179, 0, v179, s[64:65]
    v_cndmask_b32 v183, 0, v183, s[64:65]
    ds_write_b128 v174, v[176:179]
    ds_write_b128 v174, v[180:183] offset:4096
    v_mul_f32 v173, 0x41000000, v173
    v_fma_f32 v173, 4.0, v172, v173
    v_mul_f32 v167, 0x3acccccd, v166
    v_mul_f32 v168, v167, v173
    v_fmamk_f32 v169, v167, 0x00000000, v168
    v_cos_f32 v184, v169
    v_sin_f32 v188, v169
    v_fmamk_f32 v169, v167, 0x3f800000, v168
    v_cos_f32 v185, v169
    v_sin_f32 v189, v169
    v_fmamk_f32 v169, v167, 0x40000000, v168
    v_cos_f32 v186, v169
    v_sin_f32 v190, v169
    v_fmamk_f32 v169, v167, 0x40400000, v168
    v_cos_f32 v187, v169
    v_sin_f32 v191, v169
    ds_write_b128 v174, v[184:187] offset:8192
    ds_write_b128 v174, v[188:191] offset:12288
    v_cvt_f32_u32 v167, v160
    v_mul_f32 v167, 0x3d000000, v167
    v_mul_f32 v168, v167, v173
    v_fmamk_f32 v169, v167, 0x00000000, v168
    v_cos_f32 v170, v169
    v_sin_f32 v171, v169
    s_nop 0
    v_cvt_pk_f16_f32 v192, v170, v171
    v_cvt_pk_f16_f32 v196, -v171, v170
    v_fmamk_f32 v169, v167, 0x3f800000, v168
    v_cos_f32 v170, v169
    v_sin_f32 v171, v169
    s_nop 0
    v_cvt_pk_f16_f32 v193, v170, v171
    v_cvt_pk_f16_f32 v197, -v171, v170
    v_fmamk_f32 v169, v167, 0x40000000, v168
    v_cos_f32 v170, v169
    v_sin_f32 v171, v169
    s_nop 0
    v_cvt_pk_f16_f32 v194, v170, v171
    v_cvt_pk_f16_f32 v198, -v171, v170
    v_fmamk_f32 v169, v167, 0x40400000, v168
    v_cos_f32 v170, v169
    v_sin_f32 v171, v169
    s_nop 0
    v_cvt_pk_f16_f32 v195, v170, v171
    v_cvt_pk_f16_f32 v199, -v171, v170
    ds_write_b128 v174, v[192:195] offset:16384
    ds_write_b128 v174, v[196:199] offset:20480
    v_mov_b32 v202, 0
    v_mov_b32 v203, 0
    v_lshlrev_b32 v7, 4, v1
    v_add_u32 v7, 24576, v7
    v_mov_b32 v114, 0x3acccccd
    s_mov_b32 s38, 0x42000000
    s_and_b32 s26, s2, 15
    v_mul_u32_u24 v10, 21, v160
    v_mad_u32_u24 v10, v161, 10, v10
    s_mul_i32 s60, s21, 704
    s_add_u32 s60, s60, 2560
    v_add_lshl_u32 v10, v10, s60, 2
    s_waitcnt lgkmcnt(0)
    s_barrier
    ds_read_b128 v[16:19], v7 offset:0
    ds_read_b128 v[20:23], v7 offset:1024
    ds_read_b128 v[24:27], v7 offset:2048
    ds_read_b128 v[28:31], v7 offset:4096
    ds_read_b128 v[32:35], v7 offset:5120
    ds_read_b128 v[36:39], v7 offset:6144
    ds_read_b128 v[40:43], v7 offset:8192
    ds_read_b128 v[44:47], v7 offset:9216
    ds_read_b128 v[48:51], v7 offset:10240
    ds_read_b128 v[52:55], v7 offset:11264
    ds_read_b128 v[56:59], v7 offset:12288
    ds_read_b128 v[60:63], v7 offset:13312
    ds_read_b128 v[64:67], v7 offset:14336
    ds_read_b128 v[68:71], v7 offset:15360
    v_add_u32 v169, 0, v0
    v_mul_u32_u24 v170, 3277, v169
    v_lshrrev_b32 v170, 16, v170
    v_add_u32 v169, v169, v170
    v_lshlrev_b32 v169, 2, v169
    v_add_u32 v11, 10240, v169
    v_add_u32 v169, 256, v0
    v_mul_u32_u24 v170, 3277, v169
    v_lshrrev_b32 v170, 16, v170
    v_add_u32 v169, v169, v170
    v_lshlrev_b32 v169, 2, v169
    v_add_u32 v12, 10240, v169
    v_add_u32 v169, 512, v0
    v_mul_u32_u24 v170, 3277, v169
    v_lshrrev_b32 v170, 16, v170
    v_add_u32 v169, v169, v170
    v_lshlrev_b32 v169, 2, v169
    v_add_u32 v13, 10240, v169
    v_lshlrev_b32 v15, 4, v1
    v_lshlrev_b32 v252, 2, v1
    v_add_u32 v252, 1024, v252
    s_mul_i32 s30, s25, 2688
    s_add_u32 s30, s30, 9437184
    s_add_u32 s31, s30, 172032
    s_waitcnt vmcnt(3)
    v_readfirstlane_b32 s20, v136
    s_nop 0
    s_add_u32 s20, s20, 0x9e3779b9
    v_readfirstlane_b32 s32, v116
    v_readfirstlane_b32 s33, v117
    s_nop 1
    v_pk_add_f32 v[160:161], v[116:117], s[32:33] neg_lo:[0,1] neg_hi:[0,1]
    v_pk_mul_f32 v[162:163], v[160:161], v[160:161]
    v_pk_add_f32 v[164:165], v[118:119], s[32:33] neg_lo:[0,1] neg_hi:[0,1]
    v_pk_add_f32 v[160:161], v[160:161], v[164:165]
    v_pk_fma_f32 v[162:163], v[164:165], v[164:165], v[162:163]
    v_pk_add_f32 v[166:167], v[120:121], s[32:33] neg_lo:[0,1] neg_hi:[0,1]
    v_pk_add_f32 v[160:161], v[160:161], v[166:167]
    v_pk_fma_f32 v[162:163], v[166:167], v[166:167], v[162:163]
    v_pk_add_f32 v[164:165], v[122:123], s[32:33] neg_lo:[0,1] neg_hi:[0,1]
    v_pk_add_f32 v[160:161], v[160:161], v[164:165]
    v_pk_fma_f32 v[162:163], v[164:165], v[164:165], v[162:163]
    v_pk_add_f32 v[166:167], v[124:125], s[32:33] neg_lo:[0,1] neg_hi:[0,1]
    v_pk_add_f32 v[160:161], v[160:161], v[166:167]
    v_pk_fma_f32 v[162:163], v[166:167], v[166:167], v[162:163]
    v_pk_add_f32 v[164:165], v[126:127], s[32:33] neg_lo:[0,1] neg_hi:[0,1]
    v_pk_add_f32 v[160:161], v[160:161], v[164:165]
    v_pk_fma_f32 v[162:163], v[164:165], v[164:165], v[162:163]
    v_pk_add_f32 v[166:167], v[128:129], s[32:33] neg_lo:[0,1] neg_hi:[0,1]
    v_pk_add_f32 v[160:161], v[160:161], v[166:167]
    v_pk_fma_f32 v[162:163], v[166:167], v[166:167], v[162:163]
    v_pk_add_f32 v[164:165], v[130:131], s[32:33] neg_lo:[0,1] neg_hi:[0,1]
    v_pk_add_f32 v[160:161], v[160:161], v[164:165]
    v_pk_fma_f32 v[162:163], v[164:165], v[164:165], v[162:163]
    v_pk_add_f32 v[166:167], v[132:133], s[32:33] neg_lo:[0,1] neg_hi:[0,1]
    v_pk_add_f32 v[160:161], v[160:161], v[166:167]
    v_pk_fma_f32 v[162:163], v[166:167], v[166:167], v[162:163]
    v_pk_add_f32 v[164:165], v[134:135], s[32:33] neg_lo:[0,1] neg_hi:[0,1]
    v_pk_add_f32 v[160:161], v[160:161], v[164:165]
    v_pk_fma_f32 v[162:163], v[164:165], v[164:165], v[162:163]
    s_nop 0
    v_permlane32_swap_b32 v160, v161
    v_permlane32_swap_b32 v162, v163
    v_add_f32 v160, v160, v161
    v_add_f32 v162, v162, v163
    s_nop 1
    v_permlane16_swap_b32 v160, v162
    v_add_f32 v160, v160, v162
    s_nop 1
    v_add_f32_dpp v160, v160, v160 row_ror:8 row_mask:0xf bank_mask:0xf
    s_nop 1
    v_add_f32_dpp v160, v160, v160 row_ror:4 row_mask:0xf bank_mask:0xf
    s_nop 1
    v_add_f32_dpp v160, v160, v160 row_ror:2 row_mask:0xf bank_mask:0xf
    s_nop 1
    v_add_f32_dpp v160, v160, v160 row_ror:1 row_mask:0xf bank_mask:0xf
    s_nop 0
    v_readlane_b32 s34, v160, 0
    v_readlane_b32 s35, v160, 32
    v_readlane_b32 s36, v160, 16
    v_readlane_b32 s37, v160, 48
    v_pk_mul_f32 v[156:157], s[34:35], v[114:115] op_sel_hi:[1,0]
    s_nop 0
    v_pk_mul_f32 v[158:159], s[36:37], v[114:115] op_sel_hi:[1,0]
    v_pk_fma_f32 v[158:159], v[156:157], v[156:157], v[158:159] neg_lo:[1,0,0] neg_hi:[1,0,0]
    v_pk_add_f32 v[156:157], v[156:157], s[32:33]
    v_max_f32 v158, 0, v158
    v_max_f32 v159, 0, v159
    v_cvt_pk_bf16_f32 v164, v158, v159
    v_lshlrev_b32 v158, 16, v164
    v_and_b32 v159, 0xffff0000, v164
    v_add_f32 v158, 0x3727c5ac, v158
    v_add_f32 v159, 0x3727c5ac, v159
    v_cvt_pk_bf16_f32 v164, v158, v159
    v_lshlrev_b32 v158, 16, v164
    v_and_b32 v159, 0xffff0000, v164
    v_sqrt_f32 v158, v158
    v_sqrt_f32 v159, v159
    v_cvt_pk_bf16_f32 v166, v156, v157
    v_lshlrev_b32 v156, 16, v166
    v_and_b32 v157, 0xffff0000, v166
    v_cvt_pk_bf16_f32 v164, v158, v159
    v_lshlrev_b32 v158, 16, v164
    v_and_b32 v159, 0xffff0000, v164
    v_rcp_f32 v158, v158
    v_rcp_f32 v159, v159
    ds_read_b128 v[72:75], v7 offset:16384
    ds_read_b128 v[76:79], v7 offset:17408
    ds_read_b128 v[80:83], v7 offset:18432
    ds_read_b128 v[84:87], v7 offset:19456
    ds_read_b128 v[88:91], v7 offset:20480
    ds_read_b128 v[92:95], v7 offset:21504
    ds_read_b128 v[96:99], v7 offset:22528
    ds_read_b128 v[100:103], v7 offset:23552
    v_pk_mul_f32 v[160:161], v[156:157], v[158:159] neg_lo:[1,0] neg_hi:[1,0]
    v_pk_fma_f32 v[136:137], v[116:117], v[158:159], v[160:161]
    v_pk_fma_f32 v[138:139], v[118:119], v[158:159], v[160:161]
    v_pk_fma_f32 v[140:141], v[120:121], v[158:159], v[160:161]
    v_pk_fma_f32 v[142:143], v[122:123], v[158:159], v[160:161]
    v_pk_fma_f32 v[144:145], v[124:125], v[158:159], v[160:161]
    v_pk_fma_f32 v[146:147], v[126:127], v[158:159], v[160:161]
    v_pk_fma_f32 v[148:149], v[128:129], v[158:159], v[160:161]
    v_pk_fma_f32 v[150:151], v[130:131], v[158:159], v[160:161]
    v_pk_fma_f32 v[152:153], v[132:133], v[158:159], v[160:161]
    v_pk_fma_f32 v[154:155], v[134:135], v[158:159], v[160:161]
    v_cvt_pk_f16_f32 v192, v136, v137
    v_cvt_pk_f16_f32 v193, v138, v139
    v_cvt_pk_f16_f32 v194, v140, v141
    v_cvt_pk_f16_f32 v195, v142, v143
    v_cvt_pk_f16_f32 v196, v144, v145
    v_cvt_pk_f16_f32 v197, v146, v147
    v_cvt_pk_f16_f32 v198, v148, v149
    v_cvt_pk_f16_f32 v199, v150, v151
    v_cvt_pk_f16_f32 v200, v152, v153
    v_cvt_pk_f16_f32 v201, v154, v155
    s_waitcnt vmcnt(0) lgkmcnt(0)
    s_barrier
    s_cmp_lg_u32 s21, 3
    s_cbranch_scc1 Larr_2
    s_add_u32 s66, s26, 0
    s_lshl_b32 s66, s66, 7
    s_add_u32 s66, s66, 1015808
    v_mov_b32 v144, 1
    v_mov_b32 v145, 0
    v_mov_b32 v146, 0
    s_mov_b64 exec, 1
    buffer_atomic_add_x2 v[144:145], v146, s[4:7], s66 offen sc0
    s_mov_b64 exec, -1
Larr_2:
    v_mfma_f32_32x32x16_f16 v[160:175], v[192:195], v[16:19], 0
    v_mfma_f32_32x32x16_f16 v[176:191], v[192:195], v[28:31], 0
    v_mfma_f32_32x32x16_f16 v[160:175], v[196:199], v[20:23], v[160:175]
    v_mfma_f32_32x32x16_f16 v[176:191], v[196:199], v[32:35], v[176:191]
    v_mfma_f32_32x32x16_f16 v[160:175], v[200:203], v[24:27], v[160:175]
    v_mfma_f32_32x32x16_f16 v[176:191], v[200:203], v[36:39], v[176:191]
    s_nop 10
    v_pk_mul_f32 v[136:137], v[160:161], v[40:41]
    v_pk_mul_f32 v[138:139], v[176:177], v[40:41]
    v_pk_fma_f32 v[136:137], v[176:177], v[56:57], v[136:137]
    v_pk_fma_f32 v[138:139], v[160:161], v[56:57], v[138:139] neg_lo:[1,0,0] neg_hi:[1,0,0]
    v_cvt_pk_f16_f32 v204, v136, v138
    v_cvt_pk_f16_f32 v205, v137, v139
    v_pk_mul_f32 v[140:141], v[162:163], v[42:43]
    v_pk_mul_f32 v[142:143], v[178:179], v[42:43]
    v_pk_fma_f32 v[140:141], v[178:179], v[58:59], v[140:141]
    v_pk_fma_f32 v[142:143], v[162:163], v[58:59], v[142:143] neg_lo:[1,0,0] neg_hi:[1,0,0]
    v_cvt_pk_f16_f32 v206, v140, v142
    v_cvt_pk_f16_f32 v207, v141, v143
    s_nop 1
    v_mfma_f32_32x32x16_f16 v[220:235], v[204:207], v[72:75], 0
    v_mfma_f32_32x32x16_f16 v[236:251], v[204:207], v[88:91], 0
    v_pk_mul_f32 v[136:137], v[164:165], v[44:45]
    v_pk_mul_f32 v[138:139], v[180:181], v[44:45]
    v_pk_fma_f32 v[136:137], v[180:181], v[60:61], v[136:137]
    v_pk_fma_f32 v[138:139], v[164:165], v[60:61], v[138:139] neg_lo:[1,0,0] neg_hi:[1,0,0]
    v_cvt_pk_f16_f32 v208, v136, v138
    v_cvt_pk_f16_f32 v209, v137, v139
    v_pk_mul_f32 v[140:141], v[166:167], v[46:47]
    v_pk_mul_f32 v[142:143], v[182:183], v[46:47]
    v_pk_fma_f32 v[140:141], v[182:183], v[62:63], v[140:141]
    v_pk_fma_f32 v[142:143], v[166:167], v[62:63], v[142:143] neg_lo:[1,0,0] neg_hi:[1,0,0]
    v_cvt_pk_f16_f32 v210, v140, v142
    v_cvt_pk_f16_f32 v211, v141, v143
    s_nop 1
    v_mfma_f32_32x32x16_f16 v[220:235], v[208:211], v[76:79], v[220:235]
    v_mfma_f32_32x32x16_f16 v[236:251], v[208:211], v[92:95], v[236:251]
    v_pk_mul_f32 v[136:137], v[168:169], v[48:49]
    v_pk_mul_f32 v[138:139], v[184:185], v[48:49]
    v_pk_fma_f32 v[136:137], v[184:185], v[64:65], v[136:137]
    v_pk_fma_f32 v[138:139], v[168:169], v[64:65], v[138:139] neg_lo:[1,0,0] neg_hi:[1,0,0]
    v_cvt_pk_f16_f32 v212, v136, v138
    v_cvt_pk_f16_f32 v213, v137, v139
    v_pk_mul_f32 v[140:141], v[170:171], v[50:51]
    v_pk_mul_f32 v[142:143], v[186:187], v[50:51]
    v_pk_fma_f32 v[140:141], v[186:187], v[66:67], v[140:141]
    v_pk_fma_f32 v[142:143], v[170:171], v[66:67], v[142:143] neg_lo:[1,0,0] neg_hi:[1,0,0]
    v_cvt_pk_f16_f32 v214, v140, v142
    v_cvt_pk_f16_f32 v215, v141, v143
    s_nop 1
    v_mfma_f32_32x32x16_f16 v[220:235], v[212:215], v[80:83], v[220:235]
    v_mfma_f32_32x32x16_f16 v[236:251], v[212:215], v[96:99], v[236:251]
    v_pk_mul_f32 v[136:137], v[172:173], v[52:53]
    v_pk_mul_f32 v[138:139], v[188:189], v[52:53]
    v_pk_fma_f32 v[136:137], v[188:189], v[68:69], v[136:137]
    v_pk_fma_f32 v[138:139], v[172:173], v[68:69], v[138:139] neg_lo:[1,0,0] neg_hi:[1,0,0]
    v_cvt_pk_f16_f32 v216, v136, v138
    v_cvt_pk_f16_f32 v217, v137, v139
    v_pk_mul_f32 v[140:141], v[174:175], v[54:55]
    v_pk_mul_f32 v[142:143], v[190:191], v[54:55]
    v_pk_fma_f32 v[140:141], v[190:191], v[70:71], v[140:141]
    v_pk_fma_f32 v[142:143], v[174:175], v[70:71], v[142:143] neg_lo:[1,0,0] neg_hi:[1,0,0]
    v_cvt_pk_f16_f32 v218, v140, v142
    v_cvt_pk_f16_f32 v219, v141, v143
    s_nop 1
    v_mfma_f32_32x32x16_f16 v[220:235], v[216:219], v[84:87], v[220:235]
    v_mfma_f32_32x32x16_f16 v[236:251], v[216:219], v[100:103], v[236:251]
    s_cmp_lg_u32 s21, 3
    s_nop 10
    s_cbranch_scc1 Lsig_3
    s_lshl_b32 s67, s26, 6
    s_add_u32 s67, s67, 4096
    s_add_u32 s68, s20, 0
    v_lshlrev_b32 v147, 10, v1
    v_mov_b32 v148, s68
    s_mov_b32 s69, 40000
    s_waitcnt vmcnt(0)
    s_branch Lsigc_5
Lsiga_4:
    s_sub_u32 s69, s69, 1
    s_cmp_eq_u32 s69, 0
    s_cbranch_scc1 Lsig_3
    v_mov_b32 v144, 1
    v_mov_b32 v145, 0
    v_mov_b32 v146, 0
    s_mov_b64 exec, 1
    buffer_atomic_add_x2 v[144:145], v146, s[4:7], s66 offen sc0
    s_mov_b64 exec, -1
    s_waitcnt vmcnt(0)
Lsigc_5:
    v_readfirstlane_b32 s65, v145
    v_readfirstlane_b32 s64, v144
    s_cmp_lg_u32 s65, s68
    s_nop 3
    s_cbranch_scc1 Lsiga_4
    s_cmp_lg_u32 s64, 15
    s_cbranch_scc1 Lsig_3
    s_mov_b32 exec_lo, 0xffff
    s_mov_b32 exec_hi, 0x0
    buffer_store_dword v148, v147, s[4:7], s67 offen sc1
    s_mov_b64 exec, -1
Lsig_3:
    v_cvt_pk_f16_f32 v160, v220, v236
    ds_write_b32 v10, v160 offset:0
    v_cvt_pk_f16_f32 v161, v221, v237
    ds_write_b32 v10, v161 offset:4
    v_cvt_pk_f16_f32 v162, v222, v238
    ds_write_b32 v10, v162 offset:8
    v_cvt_pk_f16_f32 v163, v223, v239
    ds_write_b32 v10, v163 offset:12
    v_cvt_pk_f16_f32 v164, v224, v240
    ds_write_b32 v10, v164 offset:16
    v_cvt_pk_f16_f32 v165, v225, v241
    ds_write_b32 v10, v165 offset:20
    v_cvt_pk_f16_f32 v166, v226, v242
    ds_write_b32 v10, v166 offset:24
    v_cvt_pk_f16_f32 v167, v227, v243
    ds_write_b32 v10, v167 offset:28
    v_cvt_pk_f16_f32 v168, v228, v244
    ds_write_b32 v10, v168 offset:32
    v_cvt_pk_f16_f32 v169, v229, v245
    ds_write_b32 v10, v169 offset:36
    s_waitcnt lgkmcnt(0)
    s_barrier
    ds_read2st64_b32 v[176:177], v11 offset0:0 offset1:11
    ds_read2st64_b32 v[178:179], v11 offset0:22 offset1:33
    ds_read2st64_b32 v[180:181], v12 offset0:0 offset1:11
    ds_read2st64_b32 v[182:183], v12 offset0:22 offset1:33
    s_add_u32 s60, s29, 1048576
    s_add_u32 s62, s60, 8304
    s_waitcnt lgkmcnt(2)
    buffer_store_dwordx4 v[176:179], v14, s[4:7], s60 offen sc1
    s_waitcnt lgkmcnt(0)
    buffer_store_dwordx4 v[180:183], v115, s[4:7], s60 offen sc1
    s_cmp_ge_u32 s21, 2
    s_nop 0
    s_cbranch_scc1 Lw2_6
    ds_read2st64_b32 v[184:185], v13 offset0:0 offset1:11
    ds_read2st64_b32 v[186:187], v13 offset0:22 offset1:33
    s_waitcnt lgkmcnt(0)
    buffer_store_dwordx4 v[184:187], v14, s[4:7], s62 offen sc1
    s_nop 1
Lw2_6:
    s_mov_b32 s12, s52
    s_and_b32 s13, s53, 0xffff
    s_mov_b32 s14, 2621440
    s_mov_b32 s15, 0x00020000
    s_mov_b32 s16, s44
    s_and_b32 s17, s45, 0xffff
    s_mov_b32 s18, 1280
    s_mov_b32 s19, 0x00020000
    v_mov_b32 v104, 0
    buffer_load_short_d16_hi v104, v2, s[16:19], 0 offen offset:0
    v_mov_b32 v105, 0
    buffer_load_short_d16_hi v105, v2, s[16:19], 0 offen offset:64
    v_mov_b32 v106, 0
    buffer_load_short_d16_hi v106, v2, s[16:19], 0 offen offset:128
    v_mov_b32 v107, 0
    buffer_load_short_d16_hi v107, v2, s[16:19], 0 offen offset:192
    v_mov_b32 v108, 0
    buffer_load_short_d16_hi v108, v2, s[16:19], 0 offen offset:256
    v_mov_b32 v109, 0
    buffer_load_short_d16_hi v109, v2, s[16:19], 0 offen offset:320
    v_mov_b32 v110, 0
    buffer_load_short_d16_hi v110, v2, s[16:19], 0 offen offset:384
    v_mov_b32 v111, 0
    buffer_load_short_d16_hi v111, v2, s[16:19], 0 offen offset:448
    v_mov_b32 v112, 0
    buffer_load_short_d16_hi v112, v2, s[16:19], 0 offen offset:512
    v_mov_b32 v113, 0
    buffer_load_short_d16_hi v113, v2, s[16:19], 0 offen offset:576
    v_and_b32 v160, 31, v1
    v_lshrrev_b32 v161, 5, v1
    v_lshlrev_b32 v8, 2, v0
    v_mul_u32_u24 v9, 320, v161
    s_mul_i32 s60, s21, 640
    v_add3_u32 v9, v9, v160, s60
    v_lshlrev_b32 v9, 2, v9
    s_sub_u32 s60, 3, s23
    s_lshl_b32 s60, s60, 6
    s_sub_u32 s61, 64, s24
    s_add_u32 s60, s60, s61
    s_lshl_b32 s60, s60, 4
    s_lshl_b32 s61, s23, 4
    s_add_u32 s61, s61, 1318912
    s_cmp_eq_u32 s24, 0
    s_cselect_b32 s60, s61, s60
    s_cselect_b32 s61, 6, 12
    s_lshl_b32 s62, s22, 4
    v_lshlrev_b32 v3, 12, v0
    v_add_u32 v3, s62, v3
    v_sub_u32 v169, 384, v0
    v_lshlrev_b32 v169, s61, v169
    v_add_u32 v4, s60, v169
    v_add_u32 v170, 1048576, v3
    v_cmp_gt_u32 vcc, 64, v0
    s_nop 1
    v_cndmask_b32 v4, v4, v170, vcc
    v_sub_u32 v169, 128, v0
    v_and_b32 v169, 0xff, v169
    v_lshlrev_b32 v169, s61, v169
    v_add_u32 v5, s60, v169
    s_mul_i32 s60, s21, 5120
    s_add_u32 s60, s60, 31744
    v_lshl_add_u32 v6, v1, 4, s60
    s_and_b32 s27, s2, 15
    s_lshl_b32 s27, s27, 10
    s_waitcnt vmcnt(0)
    v_pk_mul_f32 v[160:161], v[104:105], v[104:105]
    v_pk_fma_f32 v[160:161], v[106:107], v[106:107], v[160:161]
    v_pk_fma_f32 v[160:161], v[108:109], v[108:109], v[160:161]
    v_pk_fma_f32 v[160:161], v[110:111], v[110:111], v[160:161]
    v_pk_fma_f32 v[160:161], v[112:113], v[112:113], v[160:161]
    v_add_f32 v160, v160, v161
    v_mov_b32 v161, v160
    s_nop 1
    v_permlane32_swap_b32 v160, v161
    v_add_f32 v160, v160, v161
    v_mov_b32 v161, v160
    s_nop 1
    v_permlane16_swap_b32 v160, v161
    v_add_f32 v160, v160, v161
    s_nop 1
    v_add_f32_dpp v160, v160, v160 row_ror:8 row_mask:0xf bank_mask:0xf
    s_nop 1
    v_add_f32_dpp v160, v160, v160 row_ror:4 row_mask:0xf bank_mask:0xf
    s_nop 1
    v_add_f32_dpp v160, v160, v160 row_ror:2 row_mask:0xf bank_mask:0xf
    s_nop 1
    v_add_f32_dpp v160, v160, v160 row_ror:1 row_mask:0xf bank_mask:0xf
    v_sqrt_f32 v160, v160
    s_nop 0
    v_mul_f32 v160, 0x40000000, v160
    s_nop 0
    v_readfirstlane_b32 s39, v160
    s_cmp_lg_u32 s21, 0
    s_nop 3
    s_cbranch_scc1 Lpolld_8
    s_add_u32 s60, s27, 20480
    s_add_u32 s61, s20, 1
    v_and_b32 v161, 15, v1
    v_lshlrev_b32 v161, 6, v161
    s_mov_b32 s62, 40000
    s_nop 0
Lpoll_7:
    buffer_load_dword v160, v161, s[4:7], s60 offen sc1
    s_waitcnt vmcnt(0)
    v_cmp_ne_u32 vcc, s61, v160
    s_nop 4
    s_cbranch_vccz Lpolld_8
    s_sub_u32 s62, s62, 1
    s_cmp_lg_u32 s62, 0
    s_cbranch_scc1 Lpoll_7
Lpolld_8:
    s_barrier
    s_mov_b32 s60, 6553600
    s_mov_b32 s62, 40000
    v_mov_b32 v168, 0
    v_mov_b32 v169, 0
    v_mov_b32 v170, 0
    v_mov_b32 v171, 0
    s_mov_b64 vcc, -1
    s_nop 0
Ly_9:
    s_mov_b64 exec, vcc
    buffer_load_dwordx4 v[160:163], v3, s[4:7], s60 offen sc1
    buffer_load_dwordx4 v[164:167], v4, s[4:7], s60 offen sc1
    s_cmp_ge_u32 s21, 2
    s_cbranch_scc1 Ly_10
    buffer_load_dwordx4 v[168:171], v5, s[4:7], s60 offen sc1
Ly_10:
    s_mov_b64 exec, -1
    s_waitcnt vmcnt(0)
    v_max3_u32 v176, v160, v161, v162
    v_max3_u32 v176, v176, v163, v164
    v_max3_u32 v176, v176, v165, v166
    v_max3_u32 v176, v176, v167, v168
    v_max3_u32 v176, v176, v169, v170
    v_max_u32 v176, v176, v171
    v_cmp_eq_u32 vcc, -1, v176
    s_nop 4
    s_cbranch_vccz Ly_13
    s_sub_u32 s62, s62, 1
    s_cmp_lg_u32 s62, 0
    s_cbranch_scc1 Ly_9
Ly_13:
    ds_write2st64_b32 v8, v160, v161 offset0:0 offset1:10
    ds_write2st64_b32 v8, v162, v163 offset0:20 offset1:30
    s_cmp_eq_u32 s21, 0
    s_cbranch_scc1 Ly_11
    v_alignbit_b32 v176, v167, v167, 16
    v_alignbit_b32 v177, v166, v166, 16
    v_alignbit_b32 v178, v165, v165, 16
    v_alignbit_b32 v179, v164, v164, 16
    v_mov_b32 v164, v176
    v_mov_b32 v165, v177
    v_mov_b32 v166, v178
    v_mov_b32 v167, v179
    s_nop 1
Ly_11:
    ds_write2st64_b32 v8, v164, v165 offset0:4 offset1:14
    ds_write2st64_b32 v8, v166, v167 offset0:24 offset1:34
    s_cmp_ge_u32 s21, 2
    s_cbranch_scc1 Ly_12
    v_alignbit_b32 v176, v171, v171, 16
    v_alignbit_b32 v177, v170, v170, 16
    v_alignbit_b32 v178, v169, v169, 16
    v_alignbit_b32 v179, v168, v168, 16
    ds_write2st64_b32 v8, v176, v177 offset0:8 offset1:18
    ds_write2st64_b32 v8, v178, v179 offset0:28 offset1:38
Ly_12:
    s_waitcnt lgkmcnt(0)
    s_barrier
    v_mov_b32 v204, -1
    v_mov_b32 v205, -1
    v_mov_b32 v206, -1
    v_mov_b32 v207, -1
    s_add_u32 s60, s29, 3735552
    s_add_u32 s62, s60, 8304
    buffer_store_dwordx4 v[204:207], v14, s[4:7], s60 offen sc1
    buffer_store_dwordx4 v[204:207], v115, s[4:7], s60 offen sc1
    s_cmp_ge_u32 s21, 2
    s_nop 0
    s_cbranch_scc1 Lw2_14
    buffer_store_dwordx4 v[204:207], v14, s[4:7], s62 offen sc1
    s_nop 1
Lw2_14:
    ds_read_b32 v176, v9 offset:0
    ds_read_b32 v177, v9 offset:128
    ds_read_b32 v178, v9 offset:256
    ds_read_b32 v179, v9 offset:384
    ds_read_b32 v180, v9 offset:512
    ds_read_b32 v181, v9 offset:640
    ds_read_b32 v182, v9 offset:768
    ds_read_b32 v183, v9 offset:896
    ds_read_b32 v184, v9 offset:1024
    ds_read_b32 v185, v9 offset:1152
    s_waitcnt lgkmcnt(9)
    v_fma_mix_f32 v116, v176, s38, v116 op_sel:[0,0,0] op_sel_hi:[1,0,0]
    v_fma_mix_f32 v117, v176, s38, v117 op_sel:[1,0,0] op_sel_hi:[1,0,0]
    s_waitcnt lgkmcnt(8)
    v_fma_mix_f32 v118, v177, s38, v118 op_sel:[0,0,0] op_sel_hi:[1,0,0]
    v_fma_mix_f32 v119, v177, s38, v119 op_sel:[1,0,0] op_sel_hi:[1,0,0]
    s_waitcnt lgkmcnt(7)
    v_fma_mix_f32 v120, v178, s38, v120 op_sel:[0,0,0] op_sel_hi:[1,0,0]
    v_fma_mix_f32 v121, v178, s38, v121 op_sel:[1,0,0] op_sel_hi:[1,0,0]
    s_waitcnt lgkmcnt(6)
    v_fma_mix_f32 v122, v179, s38, v122 op_sel:[0,0,0] op_sel_hi:[1,0,0]
    v_fma_mix_f32 v123, v179, s38, v123 op_sel:[1,0,0] op_sel_hi:[1,0,0]
    s_waitcnt lgkmcnt(5)
    v_fma_mix_f32 v124, v180, s38, v124 op_sel:[0,0,0] op_sel_hi:[1,0,0]
    v_fma_mix_f32 v125, v180, s38, v125 op_sel:[1,0,0] op_sel_hi:[1,0,0]
    s_waitcnt lgkmcnt(4)
    v_fma_mix_f32 v126, v181, s38, v126 op_sel:[0,0,0] op_sel_hi:[1,0,0]
    v_fma_mix_f32 v127, v181, s38, v127 op_sel:[1,0,0] op_sel_hi:[1,0,0]
    s_waitcnt lgkmcnt(3)
    v_fma_mix_f32 v128, v182, s38, v128 op_sel:[0,0,0] op_sel_hi:[1,0,0]
    v_fma_mix_f32 v129, v182, s38, v129 op_sel:[1,0,0] op_sel_hi:[1,0,0]
    s_waitcnt lgkmcnt(2)
    v_fma_mix_f32 v130, v183, s38, v130 op_sel:[0,0,0] op_sel_hi:[1,0,0]
    v_fma_mix_f32 v131, v183, s38, v131 op_sel:[1,0,0] op_sel_hi:[1,0,0]
    s_waitcnt lgkmcnt(1)
    v_fma_mix_f32 v132, v184, s38, v132 op_sel:[0,0,0] op_sel_hi:[1,0,0]
    v_fma_mix_f32 v133, v184, s38, v133 op_sel:[1,0,0] op_sel_hi:[1,0,0]
    s_waitcnt lgkmcnt(0)
    v_fma_mix_f32 v134, v185, s38, v134 op_sel:[0,0,0] op_sel_hi:[1,0,0]
    v_fma_mix_f32 v135, v185, s38, v135 op_sel:[1,0,0] op_sel_hi:[1,0,0]
    v_cvt_pk_bf16_f32 v220, v116, v118
    v_cvt_pk_bf16_f32 v228, v117, v119
    v_cvt_pk_bf16_f32 v221, v120, v122
    v_cvt_pk_bf16_f32 v229, v121, v123
    v_cvt_pk_bf16_f32 v222, v124, v126
    v_cvt_pk_bf16_f32 v230, v125, v127
    v_cvt_pk_bf16_f32 v223, v128, v130
    v_cvt_pk_bf16_f32 v231, v129, v131
    v_cvt_pk_bf16_f32 v224, v132, v134
    v_cvt_pk_bf16_f32 v232, v133, v135
    v_lshlrev_b32 v116, 16, v220
    v_and_b32 v118, 0xffff0000, v220
    v_lshlrev_b32 v117, 16, v228
    v_and_b32 v119, 0xffff0000, v228
    v_lshlrev_b32 v120, 16, v221
    v_and_b32 v122, 0xffff0000, v221
    v_lshlrev_b32 v121, 16, v229
    v_and_b32 v123, 0xffff0000, v229
    v_lshlrev_b32 v124, 16, v222
    v_and_b32 v126, 0xffff0000, v222
    v_lshlrev_b32 v125, 16, v230
    v_and_b32 v127, 0xffff0000, v230
    v_lshlrev_b32 v128, 16, v223
    v_and_b32 v130, 0xffff0000, v223
    v_lshlrev_b32 v129, 16, v231
    v_and_b32 v131, 0xffff0000, v231
    v_lshlrev_b32 v132, 16, v224
    v_and_b32 v134, 0xffff0000, v224
    v_lshlrev_b32 v133, 16, v232
    v_and_b32 v135, 0xffff0000, v232
    ds_write_b128 v6, v[220:223] offset:2048
    ds_write_b128 v6, v[228:231] offset:3072
    v_mov_b32 v226, v224
    v_mov_b32 v227, v232
    v_readfirstlane_b32 s32, v116
    v_readfirstlane_b32 s33, v117
    s_nop 1
    v_pk_add_f32 v[160:161], v[116:117], s[32:33] neg_lo:[0,1] neg_hi:[0,1]
    v_pk_mul_f32 v[162:163], v[160:161], v[160:161]
    v_pk_add_f32 v[164:165], v[118:119], s[32:33] neg_lo:[0,1] neg_hi:[0,1]
    v_pk_add_f32 v[160:161], v[160:161], v[164:165]
    v_pk_fma_f32 v[162:163], v[164:165], v[164:165], v[162:163]
    v_pk_add_f32 v[166:167], v[120:121], s[32:33] neg_lo:[0,1] neg_hi:[0,1]
    v_pk_add_f32 v[160:161], v[160:161], v[166:167]
    v_pk_fma_f32 v[162:163], v[166:167], v[166:167], v[162:163]
    v_pk_add_f32 v[164:165], v[122:123], s[32:33] neg_lo:[0,1] neg_hi:[0,1]
    v_pk_add_f32 v[160:161], v[160:161], v[164:165]
    v_pk_fma_f32 v[162:163], v[164:165], v[164:165], v[162:163]
    v_pk_add_f32 v[166:167], v[124:125], s[32:33] neg_lo:[0,1] neg_hi:[0,1]
    v_pk_add_f32 v[160:161], v[160:161], v[166:167]
    v_pk_fma_f32 v[162:163], v[166:167], v[166:167], v[162:163]
    v_pk_add_f32 v[164:165], v[126:127], s[32:33] neg_lo:[0,1] neg_hi:[0,1]
    v_pk_add_f32 v[160:161], v[160:161], v[164:165]
    v_pk_fma_f32 v[162:163], v[164:165], v[164:165], v[162:163]
    v_pk_add_f32 v[166:167], v[128:129], s[32:33] neg_lo:[0,1] neg_hi:[0,1]
    v_pk_add_f32 v[160:161], v[160:161], v[166:167]
    v_pk_fma_f32 v[162:163], v[166:167], v[166:167], v[162:163]
    v_pk_add_f32 v[164:165], v[130:131], s[32:33] neg_lo:[0,1] neg_hi:[0,1]
    v_pk_add_f32 v[160:161], v[160:161], v[164:165]
    v_pk_fma_f32 v[162:163], v[164:165], v[164:165], v[162:163]
    v_pk_add_f32 v[166:167], v[132:133], s[32:33] neg_lo:[0,1] neg_hi:[0,1]
    v_pk_add_f32 v[160:161], v[160:161], v[166:167]
    v_pk_fma_f32 v[162:163], v[166:167], v[166:167], v[162:163]
    v_pk_add_f32 v[164:165], v[134:135], s[32:33] neg_lo:[0,1] neg_hi:[0,1]
    v_pk_add_f32 v[160:161], v[160:161], v[164:165]
    v_pk_fma_f32 v[162:163], v[164:165], v[164:165], v[162:163]
    s_nop 0
    v_permlane32_swap_b32 v160, v161
    v_permlane32_swap_b32 v162, v163
    v_add_f32 v160, v160, v161
    v_add_f32 v162, v162, v163
    s_nop 1
    v_permlane16_swap_b32 v160, v162
    v_add_f32 v160, v160, v162
    s_nop 1
    v_add_f32_dpp v160, v160, v160 row_ror:8 row_mask:0xf bank_mask:0xf
    s_nop 1
    v_add_f32_dpp v160, v160, v160 row_ror:4 row_mask:0xf bank_mask:0xf
    s_nop 1
    v_add_f32_dpp v160, v160, v160 row_ror:2 row_mask:0xf bank_mask:0xf
    s_nop 1
    v_add_f32_dpp v160, v160, v160 row_ror:1 row_mask:0xf bank_mask:0xf
    s_nop 0
    v_readlane_b32 s34, v160, 0
    v_readlane_b32 s35, v160, 32
    v_readlane_b32 s36, v160, 16
    v_readlane_b32 s37, v160, 48
    v_pk_mul_f32 v[156:157], s[34:35], v[114:115] op_sel_hi:[1,0]
    s_nop 0
    v_pk_mul_f32 v[158:159], s[36:37], v[114:115] op_sel_hi:[1,0]
    v_pk_fma_f32 v[158:159], v[156:157], v[156:157], v[158:159] neg_lo:[1,0,0] neg_hi:[1,0,0]
    v_pk_add_f32 v[156:157], v[156:157], s[32:33]
    v_max_f32 v158, 0, v158
    v_max_f32 v159, 0, v159
    v_cvt_pk_bf16_f32 v164, v158, v159
    v_lshlrev_b32 v158, 16, v164
    v_and_b32 v159, 0xffff0000, v164
    v_add_f32 v158, 0x3727c5ac, v158
    v_add_f32 v159, 0x3727c5ac, v159
    v_cvt_pk_bf16_f32 v164, v158, v159
    v_lshlrev_b32 v158, 16, v164
    v_and_b32 v159, 0xffff0000, v164
    v_sqrt_f32 v158, v158
    v_sqrt_f32 v159, v159
    v_cvt_pk_bf16_f32 v166, v156, v157
    v_lshlrev_b32 v156, 16, v166
    v_and_b32 v157, 0xffff0000, v166
    v_cvt_pk_bf16_f32 v164, v158, v159
    v_lshlrev_b32 v158, 16, v164
    v_and_b32 v159, 0xffff0000, v164
    v_rcp_f32 v158, v158
    v_rcp_f32 v159, v159
    s_nop 0
    v_pk_mul_f32 v[160:161], v[156:157], v[158:159] neg_lo:[1,0] neg_hi:[1,0]
    v_pk_fma_f32 v[136:137], v[116:117], v[158:159], v[160:161]
    v_pk_fma_f32 v[138:139], v[118:119], v[158:159], v[160:161]
    v_pk_fma_f32 v[140:141], v[120:121], v[158:159], v[160:161]
    v_pk_fma_f32 v[142:143], v[122:123], v[158:159], v[160:161]
    v_pk_fma_f32 v[144:145], v[124:125], v[158:159], v[160:161]
    v_pk_fma_f32 v[146:147], v[126:127], v[158:159], v[160:161]
    v_pk_fma_f32 v[148:149], v[128:129], v[158:159], v[160:161]
    v_pk_fma_f32 v[150:151], v[130:131], v[158:159], v[160:161]
    v_pk_fma_f32 v[152:153], v[132:133], v[158:159], v[160:161]
    v_pk_fma_f32 v[154:155], v[134:135], v[158:159], v[160:161]
    v_pk_mul_f32 v[176:177], v[136:137], v[104:105] op_sel:[0,0] op_sel_hi:[1,0]
    v_pk_fma_f32 v[176:177], v[138:139], v[104:105], v[176:177] op_sel:[0,1,0] op_sel_hi:[1,1,1]
    v_pk_fma_f32 v[176:177], v[140:141], v[106:107], v[176:177] op_sel:[0,0,0] op_sel_hi:[1,0,1]
    v_pk_fma_f32 v[176:177], v[142:143], v[106:107], v[176:177] op_sel:[0,1,0] op_sel_hi:[1,1,1]
    v_pk_fma_f32 v[176:177], v[144:145], v[108:109], v[176:177] op_sel:[0,0,0] op_sel_hi:[1,0,1]
    v_pk_fma_f32 v[176:177], v[146:147], v[108:109], v[176:177] op_sel:[0,1,0] op_sel_hi:[1,1,1]
    v_pk_fma_f32 v[176:177], v[148:149], v[110:111], v[176:177] op_sel:[0,0,0] op_sel_hi:[1,0,1]
    v_pk_fma_f32 v[176:177], v[150:151], v[110:111], v[176:177] op_sel:[0,1,0] op_sel_hi:[1,1,1]
    v_pk_fma_f32 v[176:177], v[152:153], v[112:113], v[176:177] op_sel:[0,0,0] op_sel_hi:[1,0,1]
    v_pk_fma_f32 v[176:177], v[154:155], v[112:113], v[176:177] op_sel:[0,1,0] op_sel_hi:[1,1,1]
    v_cvt_pk_bf16_f32 v236, v136, v138
    v_cvt_pk_bf16_f32 v244, v137, v139
    v_permlane32_swap_b32 v176, v177
    v_add_f32 v176, v176, v177
    v_mov_b32 v177, v176
    v_cvt_pk_bf16_f32 v237, v140, v142
    v_cvt_pk_bf16_f32 v245, v141, v143
    v_permlane16_swap_b32 v176, v177
    v_add_f32 v176, v176, v177
    v_cvt_pk_bf16_f32 v238, v144, v146
    v_cvt_pk_bf16_f32 v246, v145, v147
    v_add_f32_dpp v176, v176, v176 row_ror:8 row_mask:0xf bank_mask:0xf
    v_cvt_pk_bf16_f32 v239, v148, v150
    v_cvt_pk_bf16_f32 v247, v149, v151
    v_add_f32_dpp v176, v176, v176 row_ror:4 row_mask:0xf bank_mask:0xf
    v_cvt_pk_bf16_f32 v240, v152, v154
    v_cvt_pk_bf16_f32 v248, v153, v155
    v_add_f32_dpp v176, v176, v176 row_ror:2 row_mask:0xf bank_mask:0xf
    s_nop 1
    v_add_f32_dpp v176, v176, v176 row_ror:1 row_mask:0xf bank_mask:0xf
    v_cmp_le_f32 vcc, s39, v176
    v_readlane_b32 s71, v176, 32
    s_mov_b64 s[56:57], vcc
    s_cmp_eq_u32 vcc_lo, 0
    s_nop 2
    s_cbranch_scc1 Lcand_15
    buffer_store_dwordx4 v[236:239], v15, s[4:7], s30 offen sc1
    buffer_store_dword v240, v252, s[4:7], s30 offen sc1
    s_nop 0
Lcand_15:
    s_cmp_eq_u32 vcc_hi, 0
    s_cbranch_scc1 Lcand_16
    buffer_store_dwordx4 v[244:247], v15, s[4:7], s31 offen sc1
    buffer_store_dword v248, v252, s[4:7], s31 offen sc1
    s_nop 0
Lcand_16:
    s_lshl_b32 s70, s21, 2
    s_add_u32 s70, s70, 52224
    v_mov_b32 v178, s70
    v_cvt_pk_bf16_f32 v176, v176, s71
    v_lshrrev_b32 v177, 15, v176
    v_and_b32 v177, 0x10001, v177
    v_mul_u32_u24 v177, 0x7fff, v177
    v_or_b32 v177, 0x80008000, v177
    v_xor_b32 v176, v176, v177
    v_min_u32 v176, -2, v176
    s_mov_b64 exec, 1
    ds_write_b32 v178, v176
    s_mov_b64 exec, -1
    s_waitcnt vmcnt(0) lgkmcnt(0)
    s_barrier
    s_cmp_lg_u32 s21, 0
    s_cbranch_scc1 Lrp_17
    ds_read_b128 v[180:183], v178
    v_lshlrev_b32 v178, 14, v1
    s_lshl_b32 s73, s22, 6
    s_add_u32 s73, s73, 655360
    s_mov_b32 exec_lo, 0xff
    s_mov_b32 exec_hi, 0x0
    s_waitcnt lgkmcnt(0)
    buffer_store_dwordx4 v[180:183], v178, s[4:7], s73 offen sc1
    s_mov_b64 exec, -1
    s_nop 0
Lrp_17:
    v_lshlrev_b32 v136, 16, v236
    v_and_b32 v138, 0xffff0000, v236
    v_lshlrev_b32 v137, 16, v244
    v_and_b32 v139, 0xffff0000, v244
    v_lshlrev_b32 v140, 16, v237
    v_and_b32 v142, 0xffff0000, v237
    v_lshlrev_b32 v141, 16, v245
    v_and_b32 v143, 0xffff0000, v245
    v_lshlrev_b32 v144, 16, v238
    v_and_b32 v146, 0xffff0000, v238
    v_lshlrev_b32 v145, 16, v246
    v_and_b32 v147, 0xffff0000, v246
    v_lshlrev_b32 v148, 16, v239
    v_and_b32 v150, 0xffff0000, v239
    v_lshlrev_b32 v149, 16, v247
    v_and_b32 v151, 0xffff0000, v247
    v_lshlrev_b32 v152, 16, v240
    v_and_b32 v154, 0xffff0000, v240
    v_lshlrev_b32 v153, 16, v248
    v_and_b32 v155, 0xffff0000, v248
    s_cmp_lg_u32 s21, 3
    s_nop 0
    s_cbranch_scc1 Larr_18
    s_add_u32 s66, s26, 32
    s_lshl_b32 s66, s66, 7
    s_add_u32 s66, s66, 1015808
    v_mov_b32 v212, 1
    v_mov_b32 v213, 0
    v_mov_b32 v214, 0
    s_mov_b64 exec, 1
    buffer_atomic_add_x2 v[212:213], v214, s[4:7], s66 offen sc0
    s_mov_b64 exec, -1
Larr_18:
    v_mov_b32 v224, v240
    v_mov_b32 v225, v248
    ds_write_b128 v6, v[236:239]
    ds_write_b128 v6, v[244:247] offset:1024
    ds_write_b128 v6, v[224:227] offset:4096
    v_pk_add_f32 v[116:117], v[116:117], v[136:137]
    v_cvt_pk_bf16_f32 v160, v116, v117
    v_lshlrev_b32 v116, 16, v160
    v_and_b32 v117, 0xffff0000, v160
    v_pk_add_f32 v[118:119], v[118:119], v[138:139]
    v_cvt_pk_bf16_f32 v161, v118, v119
    v_lshlrev_b32 v118, 16, v161
    v_and_b32 v119, 0xffff0000, v161
    v_pk_add_f32 v[120:121], v[120:121], v[140:141]
    v_cvt_pk_bf16_f32 v162, v120, v121
    v_lshlrev_b32 v120, 16, v162
    v_and_b32 v121, 0xffff0000, v162
    v_pk_add_f32 v[122:123], v[122:123], v[142:143]
    v_cvt_pk_bf16_f32 v163, v122, v123
    v_lshlrev_b32 v122, 16, v163
    v_and_b32 v123, 0xffff0000, v163
    v_pk_add_f32 v[124:125], v[124:125], v[144:145]
    v_cvt_pk_bf16_f32 v160, v124, v125
    v_lshlrev_b32 v124, 16, v160
    v_and_b32 v125, 0xffff0000, v160
    v_pk_add_f32 v[126:127], v[126:127], v[146:147]
    v_cvt_pk_bf16_f32 v161, v126, v127
    v_lshlrev_b32 v126, 16, v161
    v_and_b32 v127, 0xffff0000, v161
    v_pk_add_f32 v[128:129], v[128:129], v[148:149]
    v_cvt_pk_bf16_f32 v162, v128, v129
    v_lshlrev_b32 v128, 16, v162
    v_and_b32 v129, 0xffff0000, v162
    v_pk_add_f32 v[130:131], v[130:131], v[150:151]
    v_cvt_pk_bf16_f32 v163, v130, v131
    v_lshlrev_b32 v130, 16, v163
    v_and_b32 v131, 0xffff0000, v163
    v_pk_add_f32 v[132:133], v[132:133], v[152:153]
    v_cvt_pk_bf16_f32 v160, v132, v133
    v_lshlrev_b32 v132, 16, v160
    v_and_b32 v133, 0xffff0000, v160
    v_pk_add_f32 v[134:135], v[134:135], v[154:155]
    v_cvt_pk_bf16_f32 v161, v134, v135
    v_lshlrev_b32 v134, 16, v161
    v_and_b32 v135, 0xffff0000, v161
    v_readfirstlane_b32 s32, v116
    v_readfirstlane_b32 s33, v117
    s_nop 1
    v_pk_add_f32 v[160:161], v[116:117], s[32:33] neg_lo:[0,1] neg_hi:[0,1]
    v_pk_mul_f32 v[162:163], v[160:161], v[160:161]
    v_pk_add_f32 v[164:165], v[118:119], s[32:33] neg_lo:[0,1] neg_hi:[0,1]
    v_pk_add_f32 v[160:161], v[160:161], v[164:165]
    v_pk_fma_f32 v[162:163], v[164:165], v[164:165], v[162:163]
    v_pk_add_f32 v[166:167], v[120:121], s[32:33] neg_lo:[0,1] neg_hi:[0,1]
    v_pk_add_f32 v[160:161], v[160:161], v[166:167]
    v_pk_fma_f32 v[162:163], v[166:167], v[166:167], v[162:163]
    v_pk_add_f32 v[164:165], v[122:123], s[32:33] neg_lo:[0,1] neg_hi:[0,1]
    v_pk_add_f32 v[160:161], v[160:161], v[164:165]
    v_pk_fma_f32 v[162:163], v[164:165], v[164:165], v[162:163]
    v_pk_add_f32 v[166:167], v[124:125], s[32:33] neg_lo:[0,1] neg_hi:[0,1]
    v_pk_add_f32 v[160:161], v[160:161], v[166:167]
    v_pk_fma_f32 v[162:163], v[166:167], v[166:167], v[162:163]
    v_pk_add_f32 v[164:165], v[126:127], s[32:33] neg_lo:[0,1] neg_hi:[0,1]
    v_pk_add_f32 v[160:161], v[160:161], v[164:165]
    v_pk_fma_f32 v[162:163], v[164:165], v[164:165], v[162:163]
    v_pk_add_f32 v[166:167], v[128:129], s[32:33] neg_lo:[0,1] neg_hi:[0,1]
    v_pk_add_f32 v[160:161], v[160:161], v[166:167]
    v_pk_fma_f32 v[162:163], v[166:167], v[166:167], v[162:163]
    v_pk_add_f32 v[164:165], v[130:131], s[32:33] neg_lo:[0,1] neg_hi:[0,1]
    v_pk_add_f32 v[160:161], v[160:161], v[164:165]
    v_pk_fma_f32 v[162:163], v[164:165], v[164:165], v[162:163]
    v_pk_add_f32 v[166:167], v[132:133], s[32:33] neg_lo:[0,1] neg_hi:[0,1]
    v_pk_add_f32 v[160:161], v[160:161], v[166:167]
    v_pk_fma_f32 v[162:163], v[166:167], v[166:167], v[162:163]
    v_pk_add_f32 v[164:165], v[134:135], s[32:33] neg_lo:[0,1] neg_hi:[0,1]
    v_pk_add_f32 v[160:161], v[160:161], v[164:165]
    v_pk_fma_f32 v[162:163], v[164:165], v[164:165], v[162:163]
    s_nop 0
    v_permlane32_swap_b32 v160, v161
    v_permlane32_swap_b32 v162, v163
    v_add_f32 v160, v160, v161
    v_add_f32 v162, v162, v163
    s_nop 1
    v_permlane16_swap_b32 v160, v162
    v_add_f32 v160, v160, v162
    s_nop 1
    v_add_f32_dpp v160, v160, v160 row_ror:8 row_mask:0xf bank_mask:0xf
    s_nop 1
    v_add_f32_dpp v160, v160, v160 row_ror:4 row_mask:0xf bank_mask:0xf
    s_nop 1
    v_add_f32_dpp v160, v160, v160 row_ror:2 row_mask:0xf bank_mask:0xf
    s_nop 1
    v_add_f32_dpp v160, v160, v160 row_ror:1 row_mask:0xf bank_mask:0xf
    s_nop 0
    v_readlane_b32 s34, v160, 0
    v_readlane_b32 s35, v160, 32
    v_readlane_b32 s36, v160, 16
    v_readlane_b32 s37, v160, 48
    v_pk_mul_f32 v[156:157], s[34:35], v[114:115] op_sel_hi:[1,0]
    s_nop 0
    v_pk_mul_f32 v[158:159], s[36:37], v[114:115] op_sel_hi:[1,0]
    v_pk_fma_f32 v[158:159], v[156:157], v[156:157], v[158:159] neg_lo:[1,0,0] neg_hi:[1,0,0]
    v_pk_add_f32 v[156:157], v[156:157], s[32:33]
    v_max_f32 v158, 0, v158
    v_max_f32 v159, 0, v159
    v_cvt_pk_bf16_f32 v164, v158, v159
    v_lshlrev_b32 v158, 16, v164
    v_and_b32 v159, 0xffff0000, v164
    v_add_f32 v158, 0x3727c5ac, v158
    v_add_f32 v159, 0x3727c5ac, v159
    v_cvt_pk_bf16_f32 v164, v158, v159
    v_lshlrev_b32 v158, 16, v164
    v_and_b32 v159, 0xffff0000, v164
    v_sqrt_f32 v158, v158
    v_sqrt_f32 v159, v159
    v_cvt_pk_bf16_f32 v166, v156, v157
    v_lshlrev_b32 v156, 16, v166
    v_and_b32 v157, 0xffff0000, v166
    v_cvt_pk_bf16_f32 v164, v158, v159
    v_lshlrev_b32 v158, 16, v164
    v_and_b32 v159, 0xffff0000, v164
    v_rcp_f32 v158, v158
    v_rcp_f32 v159, v159
    s_nop 0
    v_pk_mul_f32 v[168:169], v[156:157], v[158:159] neg_lo:[1,0] neg_hi:[1,0]
    v_pk_fma_f32 v[136:137], v[116:117], v[158:159], v[168:169]
    v_pk_fma_f32 v[138:139], v[118:119], v[158:159], v[168:169]
    v_pk_fma_f32 v[140:141], v[120:121], v[158:159], v[168:169]
    v_pk_fma_f32 v[142:143], v[122:123], v[158:159], v[168:169]
    v_pk_fma_f32 v[144:145], v[124:125], v[158:159], v[168:169]
    v_pk_fma_f32 v[146:147], v[126:127], v[158:159], v[168:169]
    v_pk_fma_f32 v[148:149], v[128:129], v[158:159], v[168:169]
    v_pk_fma_f32 v[150:151], v[130:131], v[158:159], v[168:169]
    v_pk_fma_f32 v[152:153], v[132:133], v[158:159], v[168:169]
    v_pk_fma_f32 v[154:155], v[134:135], v[158:159], v[168:169]
    v_cvt_pk_f16_f32 v192, v136, v137
    v_cvt_pk_f16_f32 v193, v138, v139
    v_cvt_pk_f16_f32 v194, v140, v141
    v_cvt_pk_f16_f32 v195, v142, v143
    v_cvt_pk_f16_f32 v196, v144, v145
    v_cvt_pk_f16_f32 v197, v146, v147
    v_cvt_pk_f16_f32 v198, v148, v149
    v_cvt_pk_f16_f32 v199, v150, v151
    v_cvt_pk_f16_f32 v200, v152, v153
    v_cvt_pk_f16_f32 v201, v154, v155
    v_mfma_f32_32x32x16_f16 v[160:175], v[192:195], v[16:19], 0
    v_mfma_f32_32x32x16_f16 v[176:191], v[192:195], v[28:31], 0
    v_mfma_f32_32x32x16_f16 v[160:175], v[196:199], v[20:23], v[160:175]
    v_mfma_f32_32x32x16_f16 v[176:191], v[196:199], v[32:35], v[176:191]
    v_mfma_f32_32x32x16_f16 v[160:175], v[200:203], v[24:27], v[160:175]
    v_mfma_f32_32x32x16_f16 v[176:191], v[200:203], v[36:39], v[176:191]
    s_cmp_lg_u32 s21, 3
    s_nop 10
    s_cbranch_scc1 Lsig_19
    s_lshl_b32 s67, s26, 6
    s_add_u32 s67, s67, 36864
    s_add_u32 s68, s20, 2
    v_lshlrev_b32 v215, 10, v1
    v_mov_b32 v216, s68
    s_mov_b32 s69, 40000
    s_waitcnt vmcnt(0)
    s_branch Lsigc_21
Lsiga_20:
    s_sub_u32 s69, s69, 1
    s_cmp_eq_u32 s69, 0
    s_cbranch_scc1 Lsig_19
    v_mov_b32 v212, 1
    v_mov_b32 v213, 0
    v_mov_b32 v214, 0
    s_mov_b64 exec, 1
    buffer_atomic_add_x2 v[212:213], v214, s[4:7], s66 offen sc0
    s_mov_b64 exec, -1
    s_waitcnt vmcnt(0)
Lsigc_21:
    v_readfirstlane_b32 s65, v213
    v_readfirstlane_b32 s64, v212
    s_cmp_lg_u32 s65, s68
    s_nop 3
    s_cbranch_scc1 Lsiga_20
    s_cmp_lg_u32 s64, 15
    s_cbranch_scc1 Lsig_19
    s_mov_b32 exec_lo, 0xffff
    s_mov_b32 exec_hi, 0x0
    buffer_store_dword v216, v215, s[4:7], s67 offen sc1
    s_mov_b64 exec, -1
Lsig_19:
    v_pk_mul_f32 v[136:137], v[160:161], v[40:41]
    v_pk_mul_f32 v[138:139], v[176:177], v[40:41]
    v_pk_fma_f32 v[136:137], v[176:177], v[56:57], v[136:137]
    v_pk_fma_f32 v[138:139], v[160:161], v[56:57], v[138:139] neg_lo:[1,0,0] neg_hi:[1,0,0]
    v_cvt_pk_f16_f32 v204, v136, v138
    v_cvt_pk_f16_f32 v205, v137, v139
    v_pk_mul_f32 v[140:141], v[162:163], v[42:43]
    v_pk_mul_f32 v[142:143], v[178:179], v[42:43]
    v_pk_fma_f32 v[140:141], v[178:179], v[58:59], v[140:141]
    v_pk_fma_f32 v[142:143], v[162:163], v[58:59], v[142:143] neg_lo:[1,0,0] neg_hi:[1,0,0]
    v_cvt_pk_f16_f32 v206, v140, v142
    v_cvt_pk_f16_f32 v207, v141, v143
    s_nop 1
    v_mfma_f32_32x32x16_f16 v[220:235], v[204:207], v[72:75], 0
    v_mfma_f32_32x32x16_f16 v[236:251], v[204:207], v[88:91], 0
    v_pk_mul_f32 v[136:137], v[164:165], v[44:45]
    v_pk_mul_f32 v[138:139], v[180:181], v[44:45]
    v_pk_fma_f32 v[136:137], v[180:181], v[60:61], v[136:137]
    v_pk_fma_f32 v[138:139], v[164:165], v[60:61], v[138:139] neg_lo:[1,0,0] neg_hi:[1,0,0]
    v_cvt_pk_f16_f32 v208, v136, v138
    v_cvt_pk_f16_f32 v209, v137, v139
    v_pk_mul_f32 v[140:141], v[166:167], v[46:47]
    v_pk_mul_f32 v[142:143], v[182:183], v[46:47]
    v_pk_fma_f32 v[140:141], v[182:183], v[62:63], v[140:141]
    v_pk_fma_f32 v[142:143], v[166:167], v[62:63], v[142:143] neg_lo:[1,0,0] neg_hi:[1,0,0]
    v_cvt_pk_f16_f32 v210, v140, v142
    v_cvt_pk_f16_f32 v211, v141, v143
    s_nop 1
    v_mfma_f32_32x32x16_f16 v[220:235], v[208:211], v[76:79], v[220:235]
    v_mfma_f32_32x32x16_f16 v[236:251], v[208:211], v[92:95], v[236:251]
    v_pk_mul_f32 v[136:137], v[168:169], v[48:49]
    v_pk_mul_f32 v[138:139], v[184:185], v[48:49]
    v_pk_fma_f32 v[136:137], v[184:185], v[64:65], v[136:137]
    v_pk_fma_f32 v[138:139], v[168:169], v[64:65], v[138:139] neg_lo:[1,0,0] neg_hi:[1,0,0]
    v_cvt_pk_f16_f32 v212, v136, v138
    v_cvt_pk_f16_f32 v213, v137, v139
    v_pk_mul_f32 v[140:141], v[170:171], v[50:51]
    v_pk_mul_f32 v[142:143], v[186:187], v[50:51]
    v_pk_fma_f32 v[140:141], v[186:187], v[66:67], v[140:141]
    v_pk_fma_f32 v[142:143], v[170:171], v[66:67], v[142:143] neg_lo:[1,0,0] neg_hi:[1,0,0]
    v_cvt_pk_f16_f32 v214, v140, v142
    v_cvt_pk_f16_f32 v215, v141, v143
    s_nop 1
    v_mfma_f32_32x32x16_f16 v[220:235], v[212:215], v[80:83], v[220:235]
    v_mfma_f32_32x32x16_f16 v[236:251], v[212:215], v[96:99], v[236:251]
    v_pk_mul_f32 v[136:137], v[172:173], v[52:53]
    v_pk_mul_f32 v[138:139], v[188:189], v[52:53]
    v_pk_fma_f32 v[136:137], v[188:189], v[68:69], v[136:137]
    v_pk_fma_f32 v[138:139], v[172:173], v[68:69], v[138:139] neg_lo:[1,0,0] neg_hi:[1,0,0]
    v_cvt_pk_f16_f32 v216, v136, v138
    v_cvt_pk_f16_f32 v217, v137, v139
    v_pk_mul_f32 v[140:141], v[174:175], v[54:55]
    v_pk_mul_f32 v[142:143], v[190:191], v[54:55]
    v_pk_fma_f32 v[140:141], v[190:191], v[70:71], v[140:141]
    v_pk_fma_f32 v[142:143], v[174:175], v[70:71], v[142:143] neg_lo:[1,0,0] neg_hi:[1,0,0]
    v_cvt_pk_f16_f32 v218, v140, v142
    v_cvt_pk_f16_f32 v219, v141, v143
    s_nop 1
    v_mfma_f32_32x32x16_f16 v[220:235], v[216:219], v[84:87], v[220:235]
    v_mfma_f32_32x32x16_f16 v[236:251], v[216:219], v[100:103], v[236:251]
    s_nop 11
    v_cvt_pk_f16_f32 v160, v220, v236
    ds_write_b32 v10, v160 offset:0
    v_cvt_pk_f16_f32 v161, v221, v237
    ds_write_b32 v10, v161 offset:4
    v_cvt_pk_f16_f32 v162, v222, v238
    ds_write_b32 v10, v162 offset:8
    v_cvt_pk_f16_f32 v163, v223, v239
    ds_write_b32 v10, v163 offset:12
    v_cvt_pk_f16_f32 v164, v224, v240
    ds_write_b32 v10, v164 offset:16
    v_cvt_pk_f16_f32 v165, v225, v241
    ds_write_b32 v10, v165 offset:20
    v_cvt_pk_f16_f32 v166, v226, v242
    ds_write_b32 v10, v166 offset:24
    v_cvt_pk_f16_f32 v167, v227, v243
    ds_write_b32 v10, v167 offset:28
    v_cvt_pk_f16_f32 v168, v228, v244
    ds_write_b32 v10, v168 offset:32
    v_cvt_pk_f16_f32 v169, v229, v245
    ds_write_b32 v10, v169 offset:36
    s_waitcnt lgkmcnt(0)
    s_barrier
    ds_read2st64_b32 v[176:177], v11 offset0:0 offset1:11
    ds_read2st64_b32 v[178:179], v11 offset0:22 offset1:33
    ds_read2st64_b32 v[180:181], v12 offset0:0 offset1:11
    ds_read2st64_b32 v[182:183], v12 offset0:22 offset1:33
    s_add_u32 s60, s29, 3735552
    s_add_u32 s62, s60, 8304
    s_waitcnt lgkmcnt(2)
    buffer_store_dwordx4 v[176:179], v14, s[4:7], s60 offen sc1
    s_waitcnt lgkmcnt(0)
    buffer_store_dwordx4 v[180:183], v115, s[4:7], s60 offen sc1
    s_cmp_ge_u32 s21, 2
    s_nop 0
    s_cbranch_scc1 Lw2_22
    ds_read2st64_b32 v[184:185], v13 offset0:0 offset1:11
    ds_read2st64_b32 v[186:187], v13 offset0:22 offset1:33
    s_waitcnt lgkmcnt(0)
    buffer_store_dwordx4 v[184:187], v14, s[4:7], s62 offen sc1
    s_nop 1
Lw2_22:
    s_mov_b32 s74, 589824
    s_cmp_eq_u32 s56, 0
    s_cbranch_scc1 Lrel_23
    ds_read_b128 v[160:163], v6 offset:2048
    ds_read_b128 v[168:171], v6 offset:4096
    s_add_u32 s61, s20, 6
    v_mov_b32 v164, v156
    v_mov_b32 v165, v158
    v_mov_b32 v166, s61
    v_mov_b32 v167, s61
    s_waitcnt lgkmcnt(0)
    buffer_store_dwordx4 v[160:163], v15, s[4:7], s30 offen offset:1280 sc1
    buffer_store_dword v170, v252, s[4:7], s30 offen offset:1280 sc1
    s_waitcnt vmcnt(0)
    s_mov_b64 exec, 1
    buffer_store_dwordx4 v[164:167], v15, s[4:7], s30 offen offset:2560 sc1
    s_mov_b64 exec, -1
    s_nop 0
Lrel_23:
    s_cmp_eq_u32 s57, 0
    s_cbranch_scc1 Lrel_24
    ds_read_b128 v[160:163], v6 offset:3072
    ds_read_b128 v[168:171], v6 offset:4096
    s_add_u32 s61, s20, 6
    v_mov_b32 v164, v157
    v_mov_b32 v165, v159
    v_mov_b32 v166, s61
    v_mov_b32 v167, s61
    s_waitcnt lgkmcnt(0)
    buffer_store_dwordx4 v[160:163], v15, s[4:7], s31 offen offset:1280 sc1
    buffer_store_dword v171, v252, s[4:7], s31 offen offset:1280 sc1
    s_waitcnt vmcnt(0)
    s_mov_b64 exec, 1
    buffer_store_dwordx4 v[164:167], v15, s[4:7], s31 offen offset:2560 sc1
    s_mov_b64 exec, -1
    s_nop 0
Lrel_24:
    v_and_b32 v168, 31, v1
    v_lshrrev_b32 v169, 5, v1
    v_mul_u32_u24 v10, 20, v168
    v_mad_u32_u24 v10, v169, 10, v10
    v_and_b32 v7, 31, v10
    v_lshrrev_b32 v11, 5, v10
    s_lshl_b32 s60, s21, 2
    s_add_u32 s60, s60, 10240
    v_add_u32 v10, v10, v11
    v_lshl_add_u32 v10, v10, 4, s60
    v_mul_u32_u24 v11, 330, v169
    v_add_u32 v11, v11, v168
    v_sub_u32 v12, 362, v11
    v_lshlrev_b32 v11, 4, v11
    v_add_u32 v11, 10240, v11
    v_cmp_eq_u32 vcc, 0, v168
    s_nop 1
    v_addc_co_u32 v12, vcc, 0, v12, vcc
    v_lshlrev_b32 v12, 4, v12
    v_add_u32 v12, 10240, v12
    s_lshl_b32 s60, s21, 8
    v_mul_u32_u24 v13, 10240, v169
    v_lshl_add_u32 v13, v168, 3, v13
    v_add_u32 v13, s60, v13
    s_mul_i32 s60, s21, 2560
    s_add_u32 s60, s60, 21504
    v_lshl_add_u32 v14, v1, 2, s60
    s_add_u32 s75, s74, 4096
    s_add_u32 s78, s74, 8192
    s_mov_b32 s60, 610304
    v_and_b32 v176, 7, v1
    v_lshlrev_b32 v176, 2, v176
    s_mov_b32 s62, 40000
    s_nop 0
Lsel_26:
    buffer_load_dword v177, v176, s[4:7], s60 offen sc1
    s_waitcnt vmcnt(0)
    v_cmp_eq_u32 vcc, -1, v177
    s_nop 4
    s_cbranch_vccz Lseld_27
    s_sleep 4
    s_sub_u32 s62, s62, 1
    s_cmp_lg_u32 s62, 0
    s_cbranch_scc1 Lsel_26
Lseld_27:
    v_readlane_b32 s80, v177, 0
    v_readlane_b32 s81, v177, 1
    v_readlane_b32 s82, v177, 2
    v_readlane_b32 s83, v177, 3
    v_readlane_b32 s84, v177, 4
    v_readlane_b32 s85, v177, 5
    v_readlane_b32 s86, v177, 6
    v_readlane_b32 s87, v177, 7
    s_add_u32 s60, s25, 0
    s_mov_b32 s76, -1
    s_cmp_eq_u32 s60, s80
    s_cselect_b32 s76, 0, s76
    s_cmp_eq_u32 s60, s81
    s_cselect_b32 s76, 1, s76
    s_cmp_eq_u32 s60, s82
    s_cselect_b32 s76, 2, s76
    s_cmp_eq_u32 s60, s83
    s_cselect_b32 s76, 3, s76
    s_cmp_eq_u32 s60, s84
    s_cselect_b32 s76, 4, s76
    s_cmp_eq_u32 s60, s85
    s_cselect_b32 s76, 5, s76
    s_cmp_eq_u32 s60, s86
    s_cselect_b32 s76, 6, s76
    s_cmp_eq_u32 s60, s87
    s_cselect_b32 s76, 7, s76
    s_cmp_lt_i32 s76, 0
    s_cbranch_scc1 Lpush_28
    s_cmp_lg_u32 s56, 0
    s_cbranch_scc1 Lpush_28
    ds_read_b128 v[160:163], v6 offset:2048
    ds_read_b128 v[168:171], v6 offset:4096
    ds_read_b128 v[172:175], v6 offset:0
    s_add_u32 s61, s20, 6
    v_mov_b32 v164, v156
    v_mov_b32 v165, v158
    v_mov_b32 v166, s61
    v_mov_b32 v167, s61
    s_waitcnt lgkmcnt(0)
    buffer_store_dwordx4 v[172:175], v15, s[4:7], s30 offen sc1
    buffer_store_dword v168, v252, s[4:7], s30 offen sc1
    buffer_store_dwordx4 v[160:163], v15, s[4:7], s30 offen offset:1280 sc1
    buffer_store_dword v170, v252, s[4:7], s30 offen offset:1280 sc1
    s_waitcnt vmcnt(0)
    s_mov_b64 exec, 1
    buffer_store_dwordx4 v[164:167], v15, s[4:7], s30 offen offset:2560 sc1
    s_mov_b64 exec, -1
    s_nop 0
Lpush_28:
    s_add_u32 s60, s25, 64
    s_mov_b32 s77, -1
    s_cmp_eq_u32 s60, s80
    s_cselect_b32 s77, 0, s77
    s_cmp_eq_u32 s60, s81
    s_cselect_b32 s77, 1, s77
    s_cmp_eq_u32 s60, s82
    s_cselect_b32 s77, 2, s77
    s_cmp_eq_u32 s60, s83
    s_cselect_b32 s77, 3, s77
    s_cmp_eq_u32 s60, s84
    s_cselect_b32 s77, 4, s77
    s_cmp_eq_u32 s60, s85
    s_cselect_b32 s77, 5, s77
    s_cmp_eq_u32 s60, s86
    s_cselect_b32 s77, 6, s77
    s_cmp_eq_u32 s60, s87
    s_cselect_b32 s77, 7, s77
    s_cmp_lt_i32 s77, 0
    s_cbranch_scc1 Lpush_29
    s_cmp_lg_u32 s57, 0
    s_cbranch_scc1 Lpush_29
    ds_read_b128 v[160:163], v6 offset:3072
    ds_read_b128 v[168:171], v6 offset:4096
    ds_read_b128 v[172:175], v6 offset:1024
    s_add_u32 s61, s20, 6
    v_mov_b32 v164, v157
    v_mov_b32 v165, v159
    v_mov_b32 v166, s61
    v_mov_b32 v167, s61
    s_waitcnt lgkmcnt(0)
    buffer_store_dwordx4 v[172:175], v15, s[4:7], s31 offen sc1
    buffer_store_dword v169, v252, s[4:7], s31 offen sc1
    buffer_store_dwordx4 v[160:163], v15, s[4:7], s31 offen offset:1280 sc1
    buffer_store_dword v171, v252, s[4:7], s31 offen offset:1280 sc1
    s_waitcnt vmcnt(0)
    s_mov_b64 exec, 1
    buffer_store_dwordx4 v[164:167], v15, s[4:7], s31 offen offset:2560 sc1
    s_mov_b64 exec, -1
    s_nop 0
Lpush_29:
    s_add_u32 s30, s30, 5505024
    s_add_u32 s31, s31, 5505024
    v_and_b32 v204, 1, v1
    v_lshlrev_b32 v204, 6, v204
    v_add_u32 v204, s25, v204
    s_mov_b32 s64, 0x00300003
    s_mov_b32 s65, 0x30000300
    v_mul_u32_u24 v209, s80, v204
    v_and_b32 v209, 0x7ff, v209
    v_cvt_f32_u32 v209, v209
    v_mul_f32 v209, 0x3a000000, v209
    v_cos_f32 v205, v209
    v_sin_f32 v206, v209
    v_mul_u32_u24 v209, s81, v204
    v_and_b32 v209, 0x7ff, v209
    v_cvt_f32_u32 v209, v209
    v_mul_f32 v209, 0x3a000000, v209
    v_cos_f32 v207, v209
    v_sin_f32 v208, v209
    s_nop 0
    v_sub_f32 v210, v205, v208
    v_add_f32 v211, v206, v207
    v_mul_f32 v210, 0.5, v210
    v_mul_f32 v211, 0.5, v211
    v_cvt_pk_f16_f32 v148, v210, v211
    v_add_f32 v210, v205, v208
    v_sub_f32 v211, v207, v206
    v_mul_f32 v210, 0.5, v210
    v_mul_f32 v211, 0.5, v211
    v_cvt_pk_f16_f32 v152, v210, v211
    v_cndmask_b32 v148, 0, v148, s[64:65]
    v_cndmask_b32 v152, 0, v152, s[64:65]
    v_mul_u32_u24 v209, s82, v204
    v_and_b32 v209, 0x7ff, v209
    v_cvt_f32_u32 v209, v209
    v_mul_f32 v209, 0x3a000000, v209
    v_cos_f32 v205, v209
    v_sin_f32 v206, v209
    v_mul_u32_u24 v209, s83, v204
    v_and_b32 v209, 0x7ff, v209
    v_cvt_f32_u32 v209, v209
    v_mul_f32 v209, 0x3a000000, v209
    v_cos_f32 v207, v209
    v_sin_f32 v208, v209
    s_nop 0
    v_sub_f32 v210, v205, v208
    v_add_f32 v211, v206, v207
    v_mul_f32 v210, 0.5, v210
    v_mul_f32 v211, 0.5, v211
    v_cvt_pk_f16_f32 v149, v210, v211
    v_add_f32 v210, v205, v208
    v_sub_f32 v211, v207, v206
    v_mul_f32 v210, 0.5, v210
    v_mul_f32 v211, 0.5, v211
    v_cvt_pk_f16_f32 v153, v210, v211
    v_cndmask_b32 v149, 0, v149, s[64:65]
    v_cndmask_b32 v153, 0, v153, s[64:65]
    v_mul_u32_u24 v209, s84, v204
    v_and_b32 v209, 0x7ff, v209
    v_cvt_f32_u32 v209, v209
    v_mul_f32 v209, 0x3a000000, v209
    v_cos_f32 v205, v209
    v_sin_f32 v206, v209
    v_mul_u32_u24 v209, s85, v204
    v_and_b32 v209, 0x7ff, v209
    v_cvt_f32_u32 v209, v209
    v_mul_f32 v209, 0x3a000000, v209
    v_cos_f32 v207, v209
    v_sin_f32 v208, v209
    s_nop 0
    v_sub_f32 v210, v205, v208
    v_add_f32 v211, v206, v207
    v_mul_f32 v210, 0.5, v210
    v_mul_f32 v211, 0.5, v211
    v_cvt_pk_f16_f32 v150, v210, v211
    v_add_f32 v210, v205, v208
    v_sub_f32 v211, v207, v206
    v_mul_f32 v210, 0.5, v210
    v_mul_f32 v211, 0.5, v211
    v_cvt_pk_f16_f32 v154, v210, v211
    v_cndmask_b32 v150, 0, v150, s[64:65]
    v_cndmask_b32 v154, 0, v154, s[64:65]
    v_mul_u32_u24 v209, s86, v204
    v_and_b32 v209, 0x7ff, v209
    v_cvt_f32_u32 v209, v209
    v_mul_f32 v209, 0x3a000000, v209
    v_cos_f32 v205, v209
    v_sin_f32 v206, v209
    v_mul_u32_u24 v209, s87, v204
    v_and_b32 v209, 0x7ff, v209
    v_cvt_f32_u32 v209, v209
    v_mul_f32 v209, 0x3a000000, v209
    v_cos_f32 v207, v209
    v_sin_f32 v208, v209
    s_nop 0
    v_sub_f32 v210, v205, v208
    v_add_f32 v211, v206, v207
    v_mul_f32 v210, 0.5, v210
    v_mul_f32 v211, 0.5, v211
    v_cvt_pk_f16_f32 v151, v210, v211
    v_add_f32 v210, v205, v208
    v_sub_f32 v211, v207, v206
    v_mul_f32 v210, 0.5, v210
    v_mul_f32 v211, 0.5, v211
    v_cvt_pk_f16_f32 v155, v210, v211
    v_cndmask_b32 v151, 0, v151, s[64:65]
    v_cndmask_b32 v155, 0, v155, s[64:65]
    s_cmp_lg_u32 s21, 0
    s_nop 0
    s_cbranch_scc1 Lpolld_31
    s_add_u32 s60, s27, 53248
    s_add_u32 s61, s20, 3
    v_and_b32 v161, 15, v1
    v_lshlrev_b32 v161, 6, v161
    s_mov_b32 s62, 40000
    s_nop 0
Lpoll_30:
    buffer_load_dword v160, v161, s[4:7], s60 offen sc1
    s_waitcnt vmcnt(0)
    v_cmp_ne_u32 vcc, s61, v160
    s_nop 4
    s_cbranch_vccz Lpolld_31
    s_sub_u32 s62, s62, 1
    s_cmp_lg_u32 s62, 0
    s_cbranch_scc1 Lpoll_30
Lpolld_31:
    s_barrier
    s_mov_b32 s60, 7995392
    s_mov_b32 s62, 40000
    v_mov_b32 v168, 0
    v_mov_b32 v169, 0
    v_mov_b32 v170, 0
    v_mov_b32 v171, 0
    s_mov_b64 vcc, -1
    s_nop 0
Ly_32:
    s_mov_b64 exec, vcc
    buffer_load_dwordx4 v[160:163], v3, s[4:7], s60 offen sc1
    buffer_load_dwordx4 v[164:167], v4, s[4:7], s60 offen sc1
    s_cmp_ge_u32 s21, 2
    s_cbranch_scc1 Ly_33
    buffer_load_dwordx4 v[168:171], v5, s[4:7], s60 offen sc1
Ly_33:
    s_mov_b64 exec, -1
    s_waitcnt vmcnt(0)
    v_max3_u32 v176, v160, v161, v162
    v_max3_u32 v176, v176, v163, v164
    v_max3_u32 v176, v176, v165, v166
    v_max3_u32 v176, v176, v167, v168
    v_max3_u32 v176, v176, v169, v170
    v_max_u32 v176, v176, v171
    v_cmp_eq_u32 vcc, -1, v176
    s_nop 4
    s_cbranch_vccz Ly_36
    s_sub_u32 s62, s62, 1
    s_cmp_lg_u32 s62, 0
    s_cbranch_scc1 Ly_32
Ly_36:
    ds_write2st64_b32 v8, v160, v161 offset0:0 offset1:10
    ds_write2st64_b32 v8, v162, v163 offset0:20 offset1:30
    s_cmp_eq_u32 s21, 0
    s_cbranch_scc1 Ly_34
    v_alignbit_b32 v176, v167, v167, 16
    v_alignbit_b32 v177, v166, v166, 16
    v_alignbit_b32 v178, v165, v165, 16
    v_alignbit_b32 v179, v164, v164, 16
    v_mov_b32 v164, v176
    v_mov_b32 v165, v177
    v_mov_b32 v166, v178
    v_mov_b32 v167, v179
    s_nop 1
Ly_34:
    ds_write2st64_b32 v8, v164, v165 offset0:4 offset1:14
    ds_write2st64_b32 v8, v166, v167 offset0:24 offset1:34
    s_cmp_ge_u32 s21, 2
    s_cbranch_scc1 Ly_35
    v_alignbit_b32 v176, v171, v171, 16
    v_alignbit_b32 v177, v170, v170, 16
    v_alignbit_b32 v178, v169, v169, 16
    v_alignbit_b32 v179, v168, v168, 16
    ds_write2st64_b32 v8, v176, v177 offset0:8 offset1:18
    ds_write2st64_b32 v8, v178, v179 offset0:28 offset1:38
Ly_35:
    s_waitcnt lgkmcnt(0)
    s_barrier
    s_mov_b32 s62, 40000
    s_add_u32 s60, s74, 20608
    v_mov_b32 v160, 0
    s_nop 1
Lx2_37:
    buffer_load_dword v161, v160, s[4:7], s60 offen sc1
    s_waitcnt vmcnt(0)
    v_cmp_eq_u32 vcc, -1, v161
    s_nop 4
    s_cbranch_vccz Lx2d_38
    s_sleep 2
    s_sub_u32 s62, s62, 1
    s_cmp_lg_u32 s62, 0
    s_cbranch_scc1 Lx2_37
Lx2d_38:
    s_mov_b32 s62, 40000
    s_mov_b64 vcc, -1
Lx2_39:
    s_mov_b64 exec, vcc
    buffer_load_dwordx2 v[220:221], v13, s[4:7], s74 offen offset:0 sc1
    buffer_load_dwordx2 v[222:223], v13, s[4:7], s74 offen offset:1024 sc1
    buffer_load_dwordx2 v[224:225], v13, s[4:7], s74 offen offset:2048 sc1
    buffer_load_dwordx2 v[226:227], v13, s[4:7], s74 offen offset:3072 sc1
    buffer_load_dwordx2 v[228:229], v13, s[4:7], s75 offen offset:0 sc1
    buffer_load_dwordx2 v[230:231], v13, s[4:7], s75 offen offset:1024 sc1
    buffer_load_dwordx2 v[232:233], v13, s[4:7], s75 offen offset:2048 sc1
    buffer_load_dwordx2 v[234:235], v13, s[4:7], s75 offen offset:3072 sc1
    buffer_load_dwordx2 v[236:237], v13, s[4:7], s78 offen offset:0 sc1
    buffer_load_dwordx2 v[238:239], v13, s[4:7], s78 offen offset:1024 sc1
    s_mov_b64 exec, -1
    s_waitcnt vmcnt(0)
    v_max3_u32 v160, v220, v221, v222
    v_max3_u32 v160, v160, v223, v224
    v_max3_u32 v160, v160, v225, v226
    v_max3_u32 v160, v160, v227, v228
    v_max3_u32 v160, v160, v229, v230
    v_max3_u32 v160, v160, v231, v232
    v_max3_u32 v160, v160, v233, v234
    v_max3_u32 v160, v160, v235, v236
    v_max3_u32 v160, v160, v237, v238
    v_max_u32 v160, v160, v239
    v_cmp_eq_u32 vcc, -1, v160
    s_nop 4
    s_cbranch_vccz Lx2d_40
    s_sub_u32 s62, s62, 1
    s_cmp_lg_u32 s62, 0
    s_cbranch_scc1 Lx2_39
Lx2d_40:
Lx2a_25:
    v_lshlrev_b32 v172, 16, v220
    v_and_b32 v173, 0xffff0000, v220
    v_lshlrev_b32 v174, 16, v222
    v_and_b32 v175, 0xffff0000, v222
    v_lshlrev_b32 v176, 16, v224
    v_and_b32 v177, 0xffff0000, v224
    v_lshlrev_b32 v178, 16, v226
    v_and_b32 v179, 0xffff0000, v226
    v_lshlrev_b32 v180, 16, v228
    v_and_b32 v181, 0xffff0000, v228
    v_lshlrev_b32 v182, 16, v230
    v_and_b32 v183, 0xffff0000, v230
    v_lshlrev_b32 v184, 16, v232
    v_and_b32 v185, 0xffff0000, v232
    v_lshlrev_b32 v186, 16, v234
    v_and_b32 v187, 0xffff0000, v234
    v_lshlrev_b32 v188, 16, v236
    v_and_b32 v189, 0xffff0000, v236
    v_lshlrev_b32 v190, 16, v238
    v_and_b32 v191, 0xffff0000, v238
    ds_write_b32 v14, v220 offset:0
    ds_write_b32 v14, v222 offset:256
    ds_write_b32 v14, v224 offset:512
    ds_write_b32 v14, v226 offset:768
    ds_write_b32 v14, v228 offset:1024
    ds_write_b32 v14, v230 offset:1280
    ds_write_b32 v14, v232 offset:1536
    ds_write_b32 v14, v234 offset:1792
    ds_write_b32 v14, v236 offset:2048
    ds_write_b32 v14, v238 offset:2304
    v_readfirstlane_b32 s32, v172
    v_readfirstlane_b32 s33, v173
    s_nop 1
    v_pk_add_f32 v[162:163], v[172:173], s[32:33] neg_lo:[0,1] neg_hi:[0,1]
    v_pk_mul_f32 v[164:165], v[162:163], v[162:163]
    v_pk_add_f32 v[166:167], v[174:175], s[32:33] neg_lo:[0,1] neg_hi:[0,1]
    v_pk_add_f32 v[162:163], v[162:163], v[166:167]
    v_pk_fma_f32 v[164:165], v[166:167], v[166:167], v[164:165]
    v_pk_add_f32 v[168:169], v[176:177], s[32:33] neg_lo:[0,1] neg_hi:[0,1]
    v_pk_add_f32 v[162:163], v[162:163], v[168:169]
    v_pk_fma_f32 v[164:165], v[168:169], v[168:169], v[164:165]
    v_pk_add_f32 v[166:167], v[178:179], s[32:33] neg_lo:[0,1] neg_hi:[0,1]
    v_pk_add_f32 v[162:163], v[162:163], v[166:167]
    v_pk_fma_f32 v[164:165], v[166:167], v[166:167], v[164:165]
    v_pk_add_f32 v[168:169], v[180:181], s[32:33] neg_lo:[0,1] neg_hi:[0,1]
    v_pk_add_f32 v[162:163], v[162:163], v[168:169]
    v_pk_fma_f32 v[164:165], v[168:169], v[168:169], v[164:165]
    v_pk_add_f32 v[166:167], v[182:183], s[32:33] neg_lo:[0,1] neg_hi:[0,1]
    v_pk_add_f32 v[162:163], v[162:163], v[166:167]
    v_pk_fma_f32 v[164:165], v[166:167], v[166:167], v[164:165]
    v_pk_add_f32 v[168:169], v[184:185], s[32:33] neg_lo:[0,1] neg_hi:[0,1]
    v_pk_add_f32 v[162:163], v[162:163], v[168:169]
    v_pk_fma_f32 v[164:165], v[168:169], v[168:169], v[164:165]
    v_pk_add_f32 v[166:167], v[186:187], s[32:33] neg_lo:[0,1] neg_hi:[0,1]
    v_pk_add_f32 v[162:163], v[162:163], v[166:167]
    v_pk_fma_f32 v[164:165], v[166:167], v[166:167], v[164:165]
    v_pk_add_f32 v[168:169], v[188:189], s[32:33] neg_lo:[0,1] neg_hi:[0,1]
    v_pk_add_f32 v[162:163], v[162:163], v[168:169]
    v_pk_fma_f32 v[164:165], v[168:169], v[168:169], v[164:165]
    v_pk_add_f32 v[166:167], v[190:191], s[32:33] neg_lo:[0,1] neg_hi:[0,1]
    v_pk_add_f32 v[162:163], v[162:163], v[166:167]
    v_pk_fma_f32 v[164:165], v[166:167], v[166:167], v[164:165]
    s_nop 0
    v_permlane32_swap_b32 v162, v163
    v_permlane32_swap_b32 v164, v165
    v_add_f32 v162, v162, v163
    v_add_f32 v164, v164, v165
    s_nop 1
    v_permlane16_swap_b32 v162, v164
    v_add_f32 v162, v162, v164
    s_nop 1
    v_add_f32_dpp v162, v162, v162 row_ror:8 row_mask:0xf bank_mask:0xf
    s_nop 1
    v_add_f32_dpp v162, v162, v162 row_ror:4 row_mask:0xf bank_mask:0xf
    s_nop 1
    v_add_f32_dpp v162, v162, v162 row_ror:2 row_mask:0xf bank_mask:0xf
    s_nop 1
    v_add_f32_dpp v162, v162, v162 row_ror:1 row_mask:0xf bank_mask:0xf
    s_nop 0
    v_readlane_b32 s34, v162, 0
    v_readlane_b32 s35, v162, 32
    v_readlane_b32 s36, v162, 16
    v_readlane_b32 s37, v162, 48
    v_pk_mul_f32 v[156:157], s[34:35], v[114:115] op_sel_hi:[1,0]
    s_nop 0
    v_pk_mul_f32 v[158:159], s[36:37], v[114:115] op_sel_hi:[1,0]
    v_pk_fma_f32 v[158:159], v[156:157], v[156:157], v[158:159] neg_lo:[1,0,0] neg_hi:[1,0,0]
    v_pk_add_f32 v[156:157], v[156:157], s[32:33]
    v_max_f32 v158, 0, v158
    v_max_f32 v159, 0, v159
    v_cvt_pk_bf16_f32 v166, v158, v159
    v_lshlrev_b32 v158, 16, v166
    v_and_b32 v159, 0xffff0000, v166
    v_add_f32 v158, 0x3727c5ac, v158
    v_add_f32 v159, 0x3727c5ac, v159
    v_cvt_pk_bf16_f32 v166, v158, v159
    v_lshlrev_b32 v158, 16, v166
    v_and_b32 v159, 0xffff0000, v166
    v_sqrt_f32 v158, v158
    v_sqrt_f32 v159, v159
    v_cvt_pk_bf16_f32 v168, v156, v157
    v_lshlrev_b32 v156, 16, v168
    v_and_b32 v157, 0xffff0000, v168
    v_cvt_pk_bf16_f32 v166, v158, v159
    v_lshlrev_b32 v158, 16, v166
    v_and_b32 v159, 0xffff0000, v166
    v_rcp_f32 v158, v158
    v_rcp_f32 v159, v159
    s_nop 0
    v_pk_mul_f32 v[162:163], v[156:157], v[158:159] neg_lo:[1,0] neg_hi:[1,0]
    v_pk_fma_f32 v[172:173], v[172:173], v[158:159], v[162:163]
    v_pk_fma_f32 v[174:175], v[174:175], v[158:159], v[162:163]
    v_pk_fma_f32 v[176:177], v[176:177], v[158:159], v[162:163]
    v_pk_fma_f32 v[178:179], v[178:179], v[158:159], v[162:163]
    v_pk_fma_f32 v[180:181], v[180:181], v[158:159], v[162:163]
    v_pk_fma_f32 v[182:183], v[182:183], v[158:159], v[162:163]
    v_pk_fma_f32 v[184:185], v[184:185], v[158:159], v[162:163]
    v_pk_fma_f32 v[186:187], v[186:187], v[158:159], v[162:163]
    v_pk_fma_f32 v[188:189], v[188:189], v[158:159], v[162:163]
    v_pk_fma_f32 v[190:191], v[190:191], v[158:159], v[162:163]
    v_cvt_pk_f16_f32 v192, v172, v173
    v_pk_add_f16 v192, v192, v221 neg_lo:[0,1] neg_hi:[0,1]
    v_cvt_pk_f16_f32 v193, v174, v175
    v_pk_add_f16 v193, v193, v223 neg_lo:[0,1] neg_hi:[0,1]
    v_cvt_pk_f16_f32 v194, v176, v177
    v_pk_add_f16 v194, v194, v225 neg_lo:[0,1] neg_hi:[0,1]
    v_cvt_pk_f16_f32 v195, v178, v179
    v_pk_add_f16 v195, v195, v227 neg_lo:[0,1] neg_hi:[0,1]
    v_cvt_pk_f16_f32 v196, v180, v181
    v_pk_add_f16 v196, v196, v229 neg_lo:[0,1] neg_hi:[0,1]
    v_cvt_pk_f16_f32 v197, v182, v183
    v_pk_add_f16 v197, v197, v231 neg_lo:[0,1] neg_hi:[0,1]
    v_cvt_pk_f16_f32 v198, v184, v185
    v_pk_add_f16 v198, v198, v233 neg_lo:[0,1] neg_hi:[0,1]
    v_cvt_pk_f16_f32 v199, v186, v187
    v_pk_add_f16 v199, v199, v235 neg_lo:[0,1] neg_hi:[0,1]
    v_cvt_pk_f16_f32 v200, v188, v189
    v_pk_add_f16 v200, v200, v237 neg_lo:[0,1] neg_hi:[0,1]
    v_cvt_pk_f16_f32 v201, v190, v191
    v_pk_add_f16 v201, v201, v239 neg_lo:[0,1] neg_hi:[0,1]
    s_waitcnt lgkmcnt(0)
    v_mfma_f32_32x32x16_f16 v[160:175], v[192:195], v[16:19], 0
    v_mfma_f32_32x32x16_f16 v[176:191], v[192:195], v[28:31], 0
    v_mfma_f32_32x32x16_f16 v[160:175], v[196:199], v[20:23], v[160:175]
    v_mfma_f32_32x32x16_f16 v[176:191], v[196:199], v[32:35], v[176:191]
    v_mfma_f32_32x32x16_f16 v[160:175], v[200:203], v[24:27], v[160:175]
    v_mfma_f32_32x32x16_f16 v[176:191], v[200:203], v[36:39], v[176:191]
    ds_read_b32 v18, v9 offset:0
    ds_read_b32 v22, v9 offset:128
    ds_read_b32 v26, v9 offset:256
    ds_read_b32 v30, v9 offset:384
    ds_read_b32 v34, v9 offset:512
    ds_read_b32 v38, v9 offset:640
    ds_read_b32 v194, v9 offset:768
    ds_read_b32 v198, v9 offset:896
    ds_read_b32 v202, v9 offset:1024
    ds_read_b32 v146, v9 offset:1152
    s_waitcnt lgkmcnt(9)
    v_fma_mix_f32 v16, v18, s38, v116 op_sel:[0,0,0] op_sel_hi:[1,0,0]
    v_fma_mix_f32 v17, v18, s38, v117 op_sel:[1,0,0] op_sel_hi:[1,0,0]
    s_waitcnt lgkmcnt(8)
    v_fma_mix_f32 v20, v22, s38, v118 op_sel:[0,0,0] op_sel_hi:[1,0,0]
    v_fma_mix_f32 v21, v22, s38, v119 op_sel:[1,0,0] op_sel_hi:[1,0,0]
    s_waitcnt lgkmcnt(7)
    v_fma_mix_f32 v24, v26, s38, v120 op_sel:[0,0,0] op_sel_hi:[1,0,0]
    v_fma_mix_f32 v25, v26, s38, v121 op_sel:[1,0,0] op_sel_hi:[1,0,0]
    s_waitcnt lgkmcnt(6)
    v_fma_mix_f32 v28, v30, s38, v122 op_sel:[0,0,0] op_sel_hi:[1,0,0]
    v_fma_mix_f32 v29, v30, s38, v123 op_sel:[1,0,0] op_sel_hi:[1,0,0]
    s_waitcnt lgkmcnt(5)
    v_fma_mix_f32 v32, v34, s38, v124 op_sel:[0,0,0] op_sel_hi:[1,0,0]
    v_fma_mix_f32 v33, v34, s38, v125 op_sel:[1,0,0] op_sel_hi:[1,0,0]
    s_waitcnt lgkmcnt(4)
    v_fma_mix_f32 v36, v38, s38, v126 op_sel:[0,0,0] op_sel_hi:[1,0,0]
    v_fma_mix_f32 v37, v38, s38, v127 op_sel:[1,0,0] op_sel_hi:[1,0,0]
    s_waitcnt lgkmcnt(3)
    v_fma_mix_f32 v192, v194, s38, v128 op_sel:[0,0,0] op_sel_hi:[1,0,0]
    v_fma_mix_f32 v193, v194, s38, v129 op_sel:[1,0,0] op_sel_hi:[1,0,0]
    s_waitcnt lgkmcnt(2)
    v_fma_mix_f32 v196, v198, s38, v130 op_sel:[0,0,0] op_sel_hi:[1,0,0]
    v_fma_mix_f32 v197, v198, s38, v131 op_sel:[1,0,0] op_sel_hi:[1,0,0]
    s_waitcnt lgkmcnt(1)
    v_fma_mix_f32 v200, v202, s38, v132 op_sel:[0,0,0] op_sel_hi:[1,0,0]
    v_fma_mix_f32 v201, v202, s38, v133 op_sel:[1,0,0] op_sel_hi:[1,0,0]
    s_waitcnt lgkmcnt(0)
    v_fma_mix_f32 v144, v146, s38, v134 op_sel:[0,0,0] op_sel_hi:[1,0,0]
    v_fma_mix_f32 v145, v146, s38, v135 op_sel:[1,0,0] op_sel_hi:[1,0,0]
    v_pk_mul_f32 v[136:137], v[160:161], v[40:41]
    v_pk_mul_f32 v[138:139], v[176:177], v[40:41]
    v_pk_fma_f32 v[136:137], v[176:177], v[56:57], v[136:137]
    v_pk_fma_f32 v[138:139], v[160:161], v[56:57], v[138:139] neg_lo:[1,0,0] neg_hi:[1,0,0]
    v_cvt_pk_f16_f32 v204, v136, v138
    v_cvt_pk_f16_f32 v205, v137, v139
    v_pk_mul_f32 v[140:141], v[162:163], v[42:43]
    v_pk_mul_f32 v[142:143], v[178:179], v[42:43]
    v_pk_fma_f32 v[140:141], v[178:179], v[58:59], v[140:141]
    v_pk_fma_f32 v[142:143], v[162:163], v[58:59], v[142:143] neg_lo:[1,0,0] neg_hi:[1,0,0]
    v_cvt_pk_f16_f32 v206, v140, v142
    v_cvt_pk_f16_f32 v207, v141, v143
    s_nop 1
    v_mfma_f32_32x32x16_f16 v[220:235], v[204:207], v[72:75], 0
    v_mfma_f32_32x32x16_f16 v[236:251], v[204:207], v[88:91], 0
    v_pk_mul_f32 v[136:137], v[164:165], v[44:45]
    v_pk_mul_f32 v[138:139], v[180:181], v[44:45]
    v_pk_fma_f32 v[136:137], v[180:181], v[60:61], v[136:137]
    v_pk_fma_f32 v[138:139], v[164:165], v[60:61], v[138:139] neg_lo:[1,0,0] neg_hi:[1,0,0]
    v_cvt_pk_f16_f32 v208, v136, v138
    v_cvt_pk_f16_f32 v209, v137, v139
    v_pk_mul_f32 v[140:141], v[166:167], v[46:47]
    v_pk_mul_f32 v[142:143], v[182:183], v[46:47]
    v_pk_fma_f32 v[140:141], v[182:183], v[62:63], v[140:141]
    v_pk_fma_f32 v[142:143], v[166:167], v[62:63], v[142:143] neg_lo:[1,0,0] neg_hi:[1,0,0]
    v_cvt_pk_f16_f32 v210, v140, v142
    v_cvt_pk_f16_f32 v211, v141, v143
    s_nop 1
    v_mfma_f32_32x32x16_f16 v[220:235], v[208:211], v[76:79], v[220:235]
    v_mfma_f32_32x32x16_f16 v[236:251], v[208:211], v[92:95], v[236:251]
    v_pk_mul_f32 v[136:137], v[168:169], v[48:49]
    v_pk_mul_f32 v[138:139], v[184:185], v[48:49]
    v_pk_fma_f32 v[136:137], v[184:185], v[64:65], v[136:137]
    v_pk_fma_f32 v[138:139], v[168:169], v[64:65], v[138:139] neg_lo:[1,0,0] neg_hi:[1,0,0]
    v_cvt_pk_f16_f32 v212, v136, v138
    v_cvt_pk_f16_f32 v213, v137, v139
    v_pk_mul_f32 v[140:141], v[170:171], v[50:51]
    v_pk_mul_f32 v[142:143], v[186:187], v[50:51]
    v_pk_fma_f32 v[140:141], v[186:187], v[66:67], v[140:141]
    v_pk_fma_f32 v[142:143], v[170:171], v[66:67], v[142:143] neg_lo:[1,0,0] neg_hi:[1,0,0]
    v_cvt_pk_f16_f32 v214, v140, v142
    v_cvt_pk_f16_f32 v215, v141, v143
    s_nop 1
    v_mfma_f32_32x32x16_f16 v[220:235], v[212:215], v[80:83], v[220:235]
    v_mfma_f32_32x32x16_f16 v[236:251], v[212:215], v[96:99], v[236:251]
    v_pk_mul_f32 v[136:137], v[172:173], v[52:53]
    v_pk_mul_f32 v[138:139], v[188:189], v[52:53]
    v_pk_fma_f32 v[136:137], v[188:189], v[68:69], v[136:137]
    v_pk_fma_f32 v[138:139], v[172:173], v[68:69], v[138:139] neg_lo:[1,0,0] neg_hi:[1,0,0]
    v_cvt_pk_f16_f32 v216, v136, v138
    v_cvt_pk_f16_f32 v217, v137, v139
    v_pk_mul_f32 v[140:141], v[174:175], v[54:55]
    v_pk_mul_f32 v[142:143], v[190:191], v[54:55]
    v_pk_fma_f32 v[140:141], v[190:191], v[70:71], v[140:141]
    v_pk_fma_f32 v[142:143], v[174:175], v[70:71], v[142:143] neg_lo:[1,0,0] neg_hi:[1,0,0]
    v_cvt_pk_f16_f32 v218, v140, v142
    v_cvt_pk_f16_f32 v219, v141, v143
    s_nop 1
    v_mfma_f32_32x32x16_f16 v[220:235], v[216:219], v[84:87], v[220:235]
    v_mfma_f32_32x32x16_f16 v[236:251], v[216:219], v[100:103], v[236:251]
    v_add_u32 v40, 0, v7
    v_bfe_u32 v40, v40, 5, 1
    v_lshl_add_u32 v40, v40, 4, v10
    v_add_u32 v41, 1, v7
    v_bfe_u32 v41, v41, 5, 1
    v_lshl_add_u32 v41, v41, 4, v10
    v_add_u32 v42, 2, v7
    v_bfe_u32 v42, v42, 5, 1
    v_lshl_add_u32 v42, v42, 4, v10
    v_add_u32 v43, 3, v7
    v_bfe_u32 v43, v43, 5, 1
    v_lshl_add_u32 v43, v43, 4, v10
    v_add_u32 v44, 4, v7
    v_bfe_u32 v44, v44, 5, 1
    v_lshl_add_u32 v44, v44, 4, v10
    v_add_u32 v45, 5, v7
    v_bfe_u32 v45, v45, 5, 1
    v_lshl_add_u32 v45, v45, 4, v10
    v_add_u32 v46, 6, v7
    v_bfe_u32 v46, v46, 5, 1
    v_lshl_add_u32 v46, v46, 4, v10
    v_add_u32 v47, 7, v7
    v_bfe_u32 v47, v47, 5, 1
    v_lshl_add_u32 v47, v47, 4, v10
    v_add_u32 v48, 8, v7
    v_bfe_u32 v48, v48, 5, 1
    v_lshl_add_u32 v48, v48, 4, v10
    v_add_u32 v49, 9, v7
    v_bfe_u32 v49, v49, 5, 1
    v_lshl_add_u32 v49, v49, 4, v10
    v_cvt_pk_f16_f32 v160, v220, v236
    ds_write_b32 v40, v160 offset:0
    v_cvt_pk_f16_f32 v161, v221, v237
    ds_write_b32 v41, v161 offset:16
    v_cvt_pk_f16_f32 v162, v222, v238
    ds_write_b32 v42, v162 offset:32
    v_cvt_pk_f16_f32 v163, v223, v239
    ds_write_b32 v43, v163 offset:48
    v_cvt_pk_f16_f32 v164, v224, v240
    ds_write_b32 v44, v164 offset:64
    v_cvt_pk_f16_f32 v165, v225, v241
    ds_write_b32 v45, v165 offset:80
    v_cvt_pk_f16_f32 v166, v226, v242
    ds_write_b32 v46, v166 offset:96
    v_cvt_pk_f16_f32 v167, v227, v243
    ds_write_b32 v47, v167 offset:112
    v_cvt_pk_f16_f32 v168, v228, v244
    ds_write_b32 v48, v168 offset:128
    v_cvt_pk_f16_f32 v169, v229, v245
    ds_write_b32 v49, v169 offset:144
    s_mov_b64 exec, 1
    ds_write_b32 v10, v160 offset:10560
    s_mov_b64 exec, -1
    s_waitcnt lgkmcnt(0)
    s_barrier
    ds_read_b128 v[40:43], v11 offset:0
    ds_read_b128 v[44:47], v12 offset:4752
    ds_read_b128 v[48:51], v11 offset:528
    ds_read_b128 v[52:55], v12 offset:4224
    ds_read_b128 v[56:59], v11 offset:1056
    ds_read_b128 v[60:63], v12 offset:3696
    ds_read_b128 v[64:67], v11 offset:1584
    ds_read_b128 v[68:71], v12 offset:3168
    ds_read_b128 v[72:75], v11 offset:2112
    ds_read_b128 v[76:79], v12 offset:2640
    ds_read_b128 v[80:83], v11 offset:2640
    ds_read_b128 v[84:87], v12 offset:2112
    ds_read_b128 v[88:91], v11 offset:3168
    ds_read_b128 v[92:95], v12 offset:1584
    s_waitcnt lgkmcnt(12)
    v_mfma_f32_16x16x32_f16 v[16:19], v[148:151], v[40:43], v[16:19]
    v_mfma_f32_16x16x32_f16 v[16:19], v[152:155], v[44:47], v[16:19]
    ds_read_b128 v[96:99], v11 offset:3696
    ds_read_b128 v[100:103], v12 offset:1056
    s_waitcnt lgkmcnt(12)
    v_mfma_f32_16x16x32_f16 v[20:23], v[148:151], v[48:51], v[20:23]
    v_mfma_f32_16x16x32_f16 v[20:23], v[152:155], v[52:55], v[20:23]
    ds_read_b128 v[160:163], v11 offset:4224
    ds_read_b128 v[164:167], v12 offset:528
    s_waitcnt lgkmcnt(12)
    v_mfma_f32_16x16x32_f16 v[24:27], v[148:151], v[56:59], v[24:27]
    v_mfma_f32_16x16x32_f16 v[24:27], v[152:155], v[60:63], v[24:27]
    ds_read_b128 v[168:171], v11 offset:4752
    ds_read_b128 v[172:175], v12 offset:0
    s_waitcnt lgkmcnt(12)
    v_mfma_f32_16x16x32_f16 v[28:31], v[148:151], v[64:67], v[28:31]
    v_mfma_f32_16x16x32_f16 v[28:31], v[152:155], v[68:71], v[28:31]
    s_waitcnt lgkmcnt(10)
    v_mfma_f32_16x16x32_f16 v[32:35], v[148:151], v[72:75], v[32:35]
    v_mfma_f32_16x16x32_f16 v[32:35], v[152:155], v[76:79], v[32:35]
    s_waitcnt lgkmcnt(8)
    v_mfma_f32_16x16x32_f16 v[36:39], v[148:151], v[80:83], v[36:39]
    v_mfma_f32_16x16x32_f16 v[36:39], v[152:155], v[84:87], v[36:39]
    s_waitcnt lgkmcnt(6)
    v_mfma_f32_16x16x32_f16 v[192:195], v[148:151], v[88:91], v[192:195]
    v_mfma_f32_16x16x32_f16 v[192:195], v[152:155], v[92:95], v[192:195]
    s_waitcnt lgkmcnt(4)
    v_mfma_f32_16x16x32_f16 v[196:199], v[148:151], v[96:99], v[196:199]
    v_mfma_f32_16x16x32_f16 v[196:199], v[152:155], v[100:103], v[196:199]
    s_waitcnt lgkmcnt(2)
    v_mfma_f32_16x16x32_f16 v[200:203], v[148:151], v[160:163], v[200:203]
    v_mfma_f32_16x16x32_f16 v[200:203], v[152:155], v[164:167], v[200:203]
    s_waitcnt lgkmcnt(0)
    v_mfma_f32_16x16x32_f16 v[144:147], v[148:151], v[168:171], v[144:147]
    v_mfma_f32_16x16x32_f16 v[144:147], v[152:155], v[172:175], v[144:147]
    s_cmp_lt_i32 s76, 0
    s_nop 6
    s_cbranch_scc1 Lown_41
    s_lshr_b32 s62, s76, 1
    s_mul_i32 s62, s62, 2560
    s_add_u32 s62, s62, 21504
    s_and_b32 s61, s76, 1
    s_lshl_b32 s61, s61, 4
    s_sub_u32 s61, 16, s61
    v_lshl_add_u32 v240, v1, 2, s62
    ds_read_b32 v241, v240 offset:0
    ds_read_b32 v242, v240 offset:256
    ds_read_b32 v243, v240 offset:512
    ds_read_b32 v244, v240 offset:768
    ds_read_b32 v245, v240 offset:1024
    ds_read_b32 v246, v240 offset:1280
    ds_read_b32 v247, v240 offset:1536
    ds_read_b32 v248, v240 offset:1792
    ds_read_b32 v249, v240 offset:2048
    ds_read_b32 v250, v240 offset:2304
    s_waitcnt lgkmcnt(0)
    v_lshlrev_b32 v241, s61, v241
    v_and_b32 v241, 0xffff0000, v241
    v_sub_f32 v241, v241, v116
    v_add_f32 v16, v16, v241
    v_lshlrev_b32 v242, s61, v242
    v_and_b32 v242, 0xffff0000, v242
    v_sub_f32 v242, v242, v118
    v_add_f32 v20, v20, v242
    v_lshlrev_b32 v243, s61, v243
    v_and_b32 v243, 0xffff0000, v243
    v_sub_f32 v243, v243, v120
    v_add_f32 v24, v24, v243
    v_lshlrev_b32 v244, s61, v244
    v_and_b32 v244, 0xffff0000, v244
    v_sub_f32 v244, v244, v122
    v_add_f32 v28, v28, v244
    v_lshlrev_b32 v245, s61, v245
    v_and_b32 v245, 0xffff0000, v245
    v_sub_f32 v245, v245, v124
    v_add_f32 v32, v32, v245
    v_lshlrev_b32 v246, s61, v246
    v_and_b32 v246, 0xffff0000, v246
    v_sub_f32 v246, v246, v126
    v_add_f32 v36, v36, v246
    v_lshlrev_b32 v247, s61, v247
    v_and_b32 v247, 0xffff0000, v247
    v_sub_f32 v247, v247, v128
    v_add_f32 v192, v192, v247
    v_lshlrev_b32 v248, s61, v248
    v_and_b32 v248, 0xffff0000, v248
    v_sub_f32 v248, v248, v130
    v_add_f32 v196, v196, v248
    v_lshlrev_b32 v249, s61, v249
    v_and_b32 v249, 0xffff0000, v249
    v_sub_f32 v249, v249, v132
    v_add_f32 v200, v200, v249
    v_lshlrev_b32 v250, s61, v250
    v_and_b32 v250, 0xffff0000, v250
    v_sub_f32 v250, v250, v134
    v_add_f32 v144, v144, v250
    s_nop 1
Lown_41:
    s_cmp_lt_i32 s77, 0
    s_cbranch_scc1 Lown_42
    s_lshr_b32 s62, s77, 1
    s_mul_i32 s62, s62, 2560
    s_add_u32 s62, s62, 21504
    s_and_b32 s61, s77, 1
    s_lshl_b32 s61, s61, 4
    s_sub_u32 s61, 16, s61
    v_lshl_add_u32 v240, v1, 2, s62
    ds_read_b32 v241, v240 offset:0
    ds_read_b32 v242, v240 offset:256
    ds_read_b32 v243, v240 offset:512
    ds_read_b32 v244, v240 offset:768
    ds_read_b32 v245, v240 offset:1024
    ds_read_b32 v246, v240 offset:1280
    ds_read_b32 v247, v240 offset:1536
    ds_read_b32 v248, v240 offset:1792
    ds_read_b32 v249, v240 offset:2048
    ds_read_b32 v250, v240 offset:2304
    s_waitcnt lgkmcnt(0)
    v_lshlrev_b32 v241, s61, v241
    v_and_b32 v241, 0xffff0000, v241
    v_sub_f32 v241, v241, v117
    v_add_f32 v17, v17, v241
    v_lshlrev_b32 v242, s61, v242
    v_and_b32 v242, 0xffff0000, v242
    v_sub_f32 v242, v242, v119
    v_add_f32 v21, v21, v242
    v_lshlrev_b32 v243, s61, v243
    v_and_b32 v243, 0xffff0000, v243
    v_sub_f32 v243, v243, v121
    v_add_f32 v25, v25, v243
    v_lshlrev_b32 v244, s61, v244
    v_and_b32 v244, 0xffff0000, v244
    v_sub_f32 v244, v244, v123
    v_add_f32 v29, v29, v244
    v_lshlrev_b32 v245, s61, v245
    v_and_b32 v245, 0xffff0000, v245
    v_sub_f32 v245, v245, v125
    v_add_f32 v33, v33, v245
    v_lshlrev_b32 v246, s61, v246
    v_and_b32 v246, 0xffff0000, v246
    v_sub_f32 v246, v246, v127
    v_add_f32 v37, v37, v246
    v_lshlrev_b32 v247, s61, v247
    v_and_b32 v247, 0xffff0000, v247
    v_sub_f32 v247, v247, v129
    v_add_f32 v193, v193, v247
    v_lshlrev_b32 v248, s61, v248
    v_and_b32 v248, 0xffff0000, v248
    v_sub_f32 v248, v248, v131
    v_add_f32 v197, v197, v248
    v_lshlrev_b32 v249, s61, v249
    v_and_b32 v249, 0xffff0000, v249
    v_sub_f32 v249, v249, v133
    v_add_f32 v201, v201, v249
    v_lshlrev_b32 v250, s61, v250
    v_and_b32 v250, 0xffff0000, v250
    v_sub_f32 v250, v250, v135
    v_add_f32 v145, v145, v250
    s_nop 1
Lown_42:
    v_cvt_pk_bf16_f32 v220, v16, v20
    v_cvt_pk_bf16_f32 v228, v17, v21
    v_cvt_pk_bf16_f32 v221, v24, v28
    v_cvt_pk_bf16_f32 v229, v25, v29
    v_cvt_pk_bf16_f32 v222, v32, v36
    v_cvt_pk_bf16_f32 v230, v33, v37
    v_cvt_pk_bf16_f32 v223, v192, v196
    v_cvt_pk_bf16_f32 v231, v193, v197
    v_cvt_pk_bf16_f32 v224, v200, v144
    v_cvt_pk_bf16_f32 v232, v201, v145
    v_lshlrev_b32 v116, 16, v220
    v_and_b32 v118, 0xffff0000, v220
    v_lshlrev_b32 v117, 16, v228
    v_and_b32 v119, 0xffff0000, v228
    v_lshlrev_b32 v120, 16, v221
    v_and_b32 v122, 0xffff0000, v221
    v_lshlrev_b32 v121, 16, v229
    v_and_b32 v123, 0xffff0000, v229
    v_lshlrev_b32 v124, 16, v222
    v_and_b32 v126, 0xffff0000, v222
    v_lshlrev_b32 v125, 16, v230
    v_and_b32 v127, 0xffff0000, v230
    v_lshlrev_b32 v128, 16, v223
    v_and_b32 v130, 0xffff0000, v223
    v_lshlrev_b32 v129, 16, v231
    v_and_b32 v131, 0xffff0000, v231
    v_lshlrev_b32 v132, 16, v224
    v_and_b32 v134, 0xffff0000, v224
    v_lshlrev_b32 v133, 16, v232
    v_and_b32 v135, 0xffff0000, v232
    v_readfirstlane_b32 s32, v116
    v_readfirstlane_b32 s33, v117
    s_nop 1
    v_pk_add_f32 v[160:161], v[116:117], s[32:33] neg_lo:[0,1] neg_hi:[0,1]
    v_pk_mul_f32 v[162:163], v[160:161], v[160:161]
    v_pk_add_f32 v[164:165], v[118:119], s[32:33] neg_lo:[0,1] neg_hi:[0,1]
    v_pk_add_f32 v[160:161], v[160:161], v[164:165]
    v_pk_fma_f32 v[162:163], v[164:165], v[164:165], v[162:163]
    v_pk_add_f32 v[166:167], v[120:121], s[32:33] neg_lo:[0,1] neg_hi:[0,1]
    v_pk_add_f32 v[160:161], v[160:161], v[166:167]
    v_pk_fma_f32 v[162:163], v[166:167], v[166:167], v[162:163]
    v_pk_add_f32 v[164:165], v[122:123], s[32:33] neg_lo:[0,1] neg_hi:[0,1]
    v_pk_add_f32 v[160:161], v[160:161], v[164:165]
    v_pk_fma_f32 v[162:163], v[164:165], v[164:165], v[162:163]
    v_pk_add_f32 v[166:167], v[124:125], s[32:33] neg_lo:[0,1] neg_hi:[0,1]
    v_pk_add_f32 v[160:161], v[160:161], v[166:167]
    v_pk_fma_f32 v[162:163], v[166:167], v[166:167], v[162:163]
    v_pk_add_f32 v[164:165], v[126:127], s[32:33] neg_lo:[0,1] neg_hi:[0,1]
    v_pk_add_f32 v[160:161], v[160:161], v[164:165]
    v_pk_fma_f32 v[162:163], v[164:165], v[164:165], v[162:163]
    v_pk_add_f32 v[166:167], v[128:129], s[32:33] neg_lo:[0,1] neg_hi:[0,1]
    v_pk_add_f32 v[160:161], v[160:161], v[166:167]
    v_pk_fma_f32 v[162:163], v[166:167], v[166:167], v[162:163]
    v_pk_add_f32 v[164:165], v[130:131], s[32:33] neg_lo:[0,1] neg_hi:[0,1]
    v_pk_add_f32 v[160:161], v[160:161], v[164:165]
    v_pk_fma_f32 v[162:163], v[164:165], v[164:165], v[162:163]
    v_pk_add_f32 v[166:167], v[132:133], s[32:33] neg_lo:[0,1] neg_hi:[0,1]
    v_pk_add_f32 v[160:161], v[160:161], v[166:167]
    v_pk_fma_f32 v[162:163], v[166:167], v[166:167], v[162:163]
    v_pk_add_f32 v[164:165], v[134:135], s[32:33] neg_lo:[0,1] neg_hi:[0,1]
    v_pk_add_f32 v[160:161], v[160:161], v[164:165]
    v_pk_fma_f32 v[162:163], v[164:165], v[164:165], v[162:163]
    s_nop 0
    v_permlane32_swap_b32 v160, v161
    v_permlane32_swap_b32 v162, v163
    v_add_f32 v160, v160, v161
    v_add_f32 v162, v162, v163
    s_nop 1
    v_permlane16_swap_b32 v160, v162
    v_add_f32 v160, v160, v162
    s_nop 1
    v_add_f32_dpp v160, v160, v160 row_ror:8 row_mask:0xf bank_mask:0xf
    s_nop 1
    v_add_f32_dpp v160, v160, v160 row_ror:4 row_mask:0xf bank_mask:0xf
    s_nop 1
    v_add_f32_dpp v160, v160, v160 row_ror:2 row_mask:0xf bank_mask:0xf
    s_nop 1
    v_add_f32_dpp v160, v160, v160 row_ror:1 row_mask:0xf bank_mask:0xf
    s_nop 0
    v_readlane_b32 s34, v160, 0
    v_readlane_b32 s35, v160, 32
    v_readlane_b32 s36, v160, 16
    v_readlane_b32 s37, v160, 48
    v_pk_mul_f32 v[156:157], s[34:35], v[114:115] op_sel_hi:[1,0]
    s_nop 0
    v_pk_mul_f32 v[158:159], s[36:37], v[114:115] op_sel_hi:[1,0]
    v_pk_fma_f32 v[158:159], v[156:157], v[156:157], v[158:159] neg_lo:[1,0,0] neg_hi:[1,0,0]
    v_pk_add_f32 v[156:157], v[156:157], s[32:33]
    v_max_f32 v158, 0, v158
    v_max_f32 v159, 0, v159
    v_cvt_pk_bf16_f32 v164, v158, v159
    v_lshlrev_b32 v158, 16, v164
    v_and_b32 v159, 0xffff0000, v164
    v_add_f32 v158, 0x3727c5ac, v158
    v_add_f32 v159, 0x3727c5ac, v159
    v_cvt_pk_bf16_f32 v164, v158, v159
    v_lshlrev_b32 v158, 16, v164
    v_and_b32 v159, 0xffff0000, v164
    v_sqrt_f32 v158, v158
    v_sqrt_f32 v159, v159
    v_cvt_pk_bf16_f32 v166, v156, v157
    v_lshlrev_b32 v156, 16, v166
    v_and_b32 v157, 0xffff0000, v166
    v_cvt_pk_bf16_f32 v164, v158, v159
    v_lshlrev_b32 v158, 16, v164
    v_and_b32 v159, 0xffff0000, v164
    v_rcp_f32 v158, v158
    v_rcp_f32 v159, v159
    s_nop 0
    v_pk_mul_f32 v[160:161], v[156:157], v[158:159] neg_lo:[1,0] neg_hi:[1,0]
    v_pk_fma_f32 v[136:137], v[116:117], v[158:159], v[160:161]
    v_pk_fma_f32 v[138:139], v[118:119], v[158:159], v[160:161]
    v_pk_fma_f32 v[140:141], v[120:121], v[158:159], v[160:161]
    v_pk_fma_f32 v[142:143], v[122:123], v[158:159], v[160:161]
    v_pk_fma_f32 v[144:145], v[124:125], v[158:159], v[160:161]
    v_pk_fma_f32 v[146:147], v[126:127], v[158:159], v[160:161]
    v_pk_fma_f32 v[148:149], v[128:129], v[158:159], v[160:161]
    v_pk_fma_f32 v[150:151], v[130:131], v[158:159], v[160:161]
    v_pk_fma_f32 v[152:153], v[132:133], v[158:159], v[160:161]
    v_pk_fma_f32 v[154:155], v[134:135], v[158:159], v[160:161]
    v_pk_mul_f32 v[184:185], v[136:137], v[104:105] op_sel:[0,0] op_sel_hi:[1,0]
    v_pk_fma_f32 v[184:185], v[138:139], v[104:105], v[184:185] op_sel:[0,1,0] op_sel_hi:[1,1,1]
    v_pk_fma_f32 v[184:185], v[140:141], v[106:107], v[184:185] op_sel:[0,0,0] op_sel_hi:[1,0,1]
    v_pk_fma_f32 v[184:185], v[142:143], v[106:107], v[184:185] op_sel:[0,1,0] op_sel_hi:[1,1,1]
    v_pk_fma_f32 v[184:185], v[144:145], v[108:109], v[184:185] op_sel:[0,0,0] op_sel_hi:[1,0,1]
    v_pk_fma_f32 v[184:185], v[146:147], v[108:109], v[184:185] op_sel:[0,1,0] op_sel_hi:[1,1,1]
    v_pk_fma_f32 v[184:185], v[148:149], v[110:111], v[184:185] op_sel:[0,0,0] op_sel_hi:[1,0,1]
    v_pk_fma_f32 v[184:185], v[150:151], v[110:111], v[184:185] op_sel:[0,1,0] op_sel_hi:[1,1,1]
    v_pk_fma_f32 v[184:185], v[152:153], v[112:113], v[184:185] op_sel:[0,0,0] op_sel_hi:[1,0,1]
    v_pk_fma_f32 v[184:185], v[154:155], v[112:113], v[184:185] op_sel:[0,1,0] op_sel_hi:[1,1,1]
    v_cvt_pk_bf16_f32 v236, v136, v138
    v_cvt_pk_bf16_f32 v244, v137, v139
    v_permlane32_swap_b32 v184, v185
    v_add_f32 v184, v184, v185
    v_mov_b32 v185, v184
    v_cvt_pk_bf16_f32 v237, v140, v142
    v_cvt_pk_bf16_f32 v245, v141, v143
    v_permlane16_swap_b32 v184, v185
    v_add_f32 v184, v184, v185
    v_cvt_pk_bf16_f32 v238, v144, v146
    v_cvt_pk_bf16_f32 v246, v145, v147
    v_add_f32_dpp v184, v184, v184 row_ror:8 row_mask:0xf bank_mask:0xf
    v_cvt_pk_bf16_f32 v239, v148, v150
    v_cvt_pk_bf16_f32 v247, v149, v151
    v_add_f32_dpp v184, v184, v184 row_ror:4 row_mask:0xf bank_mask:0xf
    v_cvt_pk_bf16_f32 v240, v152, v154
    v_cvt_pk_bf16_f32 v248, v153, v155
    v_add_f32_dpp v184, v184, v184 row_ror:2 row_mask:0xf bank_mask:0xf
    s_nop 1
    v_add_f32_dpp v184, v184, v184 row_ror:1 row_mask:0xf bank_mask:0xf
    v_cmp_le_f32 vcc, s39, v184
    v_readlane_b32 s71, v184, 32
    s_mov_b64 s[56:57], vcc
    s_cmp_eq_u32 vcc_lo, 0
    s_nop 2
    s_cbranch_scc1 Lcand_43
    buffer_store_dwordx4 v[236:239], v15, s[4:7], s30 offen sc1
    buffer_store_dword v240, v252, s[4:7], s30 offen sc1
    s_nop 0
Lcand_43:
    s_cmp_eq_u32 vcc_hi, 0
    s_cbranch_scc1 Lcand_44
    buffer_store_dwordx4 v[244:247], v15, s[4:7], s31 offen sc1
    buffer_store_dword v248, v252, s[4:7], s31 offen sc1
    s_nop 0
Lcand_44:
    s_lshl_b32 s70, s21, 2
    s_add_u32 s70, s70, 52224
    v_mov_b32 v186, s70
    v_cvt_pk_bf16_f32 v184, v184, s71
    v_lshrrev_b32 v185, 15, v184
    v_and_b32 v185, 0x10001, v185
    v_mul_u32_u24 v185, 0x7fff, v185
    v_or_b32 v185, 0x80008000, v185
    v_xor_b32 v184, v184, v185
    v_min_u32 v184, -2, v184
    s_mov_b64 exec, 1
    ds_write_b32 v186, v184
    s_mov_b64 exec, -1
    s_waitcnt vmcnt(0) lgkmcnt(0)
    s_barrier
    s_cmp_lg_u32 s21, 0
    s_cbranch_scc1 Lrp_45
    ds_read_b128 v[188:191], v186
    v_lshlrev_b32 v186, 14, v1
    s_lshl_b32 s73, s22, 6
    s_add_u32 s73, s73, 786432
    s_mov_b32 exec_lo, 0xff
    s_mov_b32 exec_hi, 0x0
    s_waitcnt lgkmcnt(0)
    buffer_store_dwordx4 v[188:191], v186, s[4:7], s73 offen sc1
    s_mov_b64 exec, -1
    s_nop 0
Lrp_45:
    v_lshlrev_b32 v136, 16, v236
    v_and_b32 v138, 0xffff0000, v236
    v_lshlrev_b32 v137, 16, v244
    v_and_b32 v139, 0xffff0000, v244
    v_lshlrev_b32 v140, 16, v237
    v_and_b32 v142, 0xffff0000, v237
    v_lshlrev_b32 v141, 16, v245
    v_and_b32 v143, 0xffff0000, v245
    v_lshlrev_b32 v144, 16, v238
    v_and_b32 v146, 0xffff0000, v238
    v_lshlrev_b32 v145, 16, v246
    v_and_b32 v147, 0xffff0000, v246
    v_lshlrev_b32 v148, 16, v239
    v_and_b32 v150, 0xffff0000, v239
    v_lshlrev_b32 v149, 16, v247
    v_and_b32 v151, 0xffff0000, v247
    v_lshlrev_b32 v152, 16, v240
    v_and_b32 v154, 0xffff0000, v240
    v_lshlrev_b32 v153, 16, v248
    v_and_b32 v155, 0xffff0000, v248
    s_mul_i32 s60, s21, 2560
    v_add_u32 v16, s60, v2
    v_pk_add_f32 v[116:117], v[116:117], v[136:137]
    v_cvt_pk_bf16_f32 v18, v116, v117
    ds_write_b16 v16, v18 offset:0
    ds_write_b16_d16_hi v16, v18 offset:1280
    v_pk_add_f32 v[118:119], v[118:119], v[138:139]
    v_cvt_pk_bf16_f32 v19, v118, v119
    ds_write_b16 v16, v19 offset:64
    ds_write_b16_d16_hi v16, v19 offset:1344
    v_pk_add_f32 v[120:121], v[120:121], v[140:141]
    v_cvt_pk_bf16_f32 v20, v120, v121
    ds_write_b16 v16, v20 offset:128
    ds_write_b16_d16_hi v16, v20 offset:1408
    v_pk_add_f32 v[122:123], v[122:123], v[142:143]
    v_cvt_pk_bf16_f32 v21, v122, v123
    ds_write_b16 v16, v21 offset:192
    ds_write_b16_d16_hi v16, v21 offset:1472
    v_pk_add_f32 v[124:125], v[124:125], v[144:145]
    v_cvt_pk_bf16_f32 v22, v124, v125
    ds_write_b16 v16, v22 offset:256
    ds_write_b16_d16_hi v16, v22 offset:1536
    v_pk_add_f32 v[126:127], v[126:127], v[146:147]
    v_cvt_pk_bf16_f32 v23, v126, v127
    ds_write_b16 v16, v23 offset:320
    ds_write_b16_d16_hi v16, v23 offset:1600
    v_pk_add_f32 v[128:129], v[128:129], v[148:149]
    v_cvt_pk_bf16_f32 v24, v128, v129
    ds_write_b16 v16, v24 offset:384
    ds_write_b16_d16_hi v16, v24 offset:1664
    v_pk_add_f32 v[130:131], v[130:131], v[150:151]
    v_cvt_pk_bf16_f32 v25, v130, v131
    ds_write_b16 v16, v25 offset:448
    ds_write_b16_d16_hi v16, v25 offset:1728
    v_pk_add_f32 v[132:133], v[132:133], v[152:153]
    v_cvt_pk_bf16_f32 v26, v132, v133
    ds_write_b16 v16, v26 offset:512
    ds_write_b16_d16_hi v16, v26 offset:1792
    v_pk_add_f32 v[134:135], v[134:135], v[154:155]
    v_cvt_pk_bf16_f32 v27, v134, v135
    ds_write_b16 v16, v27 offset:576
    ds_write_b16_d16_hi v16, v27 offset:1856
    v_lshlrev_b32 v17, 4, v1
    v_add_u32 v16, s60, v17
    s_waitcnt lgkmcnt(0)
    ds_read_b128 v[28:31], v16 offset:0
    ds_read_b128 v[32:35], v16 offset:1024
    ds_read_b128 v[36:39], v16 offset:2048
    v_add_u32 v18, 81664, v17
    v_add_u32 v19, 1024, v17
    v_cmp_gt_u32 vcc, 16, v1
    s_nop 1
    v_cndmask_b32 v19, v18, v19, vcc
    s_waitcnt lgkmcnt(0)
    buffer_store_dwordx4 v[28:31], v17, s[12:15], s28 offen sc1
    buffer_store_dwordx4 v[32:35], v19, s[12:15], s28 offen sc1
    s_mov_b32 exec_lo, 0xffffffff
    s_mov_b32 exec_hi, 0x0
    buffer_store_dwordx4 v[36:39], v18, s[12:15], s28 offen offset:1024 sc1
    s_mov_b64 exec, -1
    s_cmp_eq_u32 s56, 0
    s_cbranch_scc1 Lrel_46
    s_add_u32 s61, s20, 7
    v_mov_b32 v164, v156
    v_mov_b32 v165, v158
    v_mov_b32 v166, s61
    v_mov_b32 v167, s61
    s_waitcnt lgkmcnt(0)
    buffer_store_dwordx4 v[220:223], v15, s[4:7], s30 offen offset:1280 sc1
    buffer_store_dword v224, v252, s[4:7], s30 offen offset:1280 sc1
    s_waitcnt vmcnt(0)
    s_mov_b64 exec, 1
    buffer_store_dwordx4 v[164:167], v15, s[4:7], s30 offen offset:2560 sc1
    s_mov_b64 exec, -1
    s_nop 0
Lrel_46:
    s_cmp_eq_u32 s57, 0
    s_cbranch_scc1 Lrel_47
    s_add_u32 s61, s20, 7
    v_mov_b32 v164, v157
    v_mov_b32 v165, v159
    v_mov_b32 v166, s61
    v_mov_b32 v167, s61
    s_waitcnt lgkmcnt(0)
    buffer_store_dwordx4 v[228:231], v15, s[4:7], s31 offen offset:1280 sc1
    buffer_store_dword v232, v252, s[4:7], s31 offen offset:1280 sc1
    s_waitcnt vmcnt(0)
    s_mov_b64 exec, 1
    buffer_store_dwordx4 v[164:167], v15, s[4:7], s31 offen offset:2560 sc1
    s_mov_b64 exec, -1
    s_nop 0
Lrel_47:
    s_mov_b32 s60, 610560
    v_and_b32 v176, 7, v1
    v_lshlrev_b32 v176, 2, v176
    s_mov_b32 s62, 40000
    s_nop 0
Lsel_48:
    buffer_load_dword v177, v176, s[4:7], s60 offen sc1
    s_waitcnt vmcnt(0)
    v_cmp_eq_u32 vcc, -1, v177
    s_nop 4
    s_cbranch_vccz Lseld_49
    s_sleep 4
    s_sub_u32 s62, s62, 1
    s_cmp_lg_u32 s62, 0
    s_cbranch_scc1 Lsel_48
Lseld_49:
    v_readlane_b32 s80, v177, 0
    v_readlane_b32 s81, v177, 1
    v_readlane_b32 s82, v177, 2
    v_readlane_b32 s83, v177, 3
    v_readlane_b32 s84, v177, 4
    v_readlane_b32 s85, v177, 5
    v_readlane_b32 s86, v177, 6
    v_readlane_b32 s87, v177, 7
    s_add_u32 s60, s25, 0
    s_mov_b32 s76, -1
    s_cmp_eq_u32 s60, s80
    s_cselect_b32 s76, 0, s76
    s_cmp_eq_u32 s60, s81
    s_cselect_b32 s76, 1, s76
    s_cmp_eq_u32 s60, s82
    s_cselect_b32 s76, 2, s76
    s_cmp_eq_u32 s60, s83
    s_cselect_b32 s76, 3, s76
    s_cmp_eq_u32 s60, s84
    s_cselect_b32 s76, 4, s76
    s_cmp_eq_u32 s60, s85
    s_cselect_b32 s76, 5, s76
    s_cmp_eq_u32 s60, s86
    s_cselect_b32 s76, 6, s76
    s_cmp_eq_u32 s60, s87
    s_cselect_b32 s76, 7, s76
    s_cmp_lt_i32 s76, 0
    s_cbranch_scc1 Lpush_50
    s_cmp_lg_u32 s56, 0
    s_cbranch_scc1 Lpush_50
    s_add_u32 s61, s20, 7
    v_mov_b32 v164, v156
    v_mov_b32 v165, v158
    v_mov_b32 v166, s61
    v_mov_b32 v167, s61
    s_waitcnt lgkmcnt(0)
    buffer_store_dwordx4 v[236:239], v15, s[4:7], s30 offen sc1
    buffer_store_dword v240, v252, s[4:7], s30 offen sc1
    buffer_store_dwordx4 v[220:223], v15, s[4:7], s30 offen offset:1280 sc1
    buffer_store_dword v224, v252, s[4:7], s30 offen offset:1280 sc1
    s_waitcnt vmcnt(0)
    s_mov_b64 exec, 1
    buffer_store_dwordx4 v[164:167], v15, s[4:7], s30 offen offset:2560 sc1
    s_mov_b64 exec, -1
    s_nop 0
Lpush_50:
    s_add_u32 s60, s25, 64
    s_mov_b32 s77, -1
    s_cmp_eq_u32 s60, s80
    s_cselect_b32 s77, 0, s77
    s_cmp_eq_u32 s60, s81
    s_cselect_b32 s77, 1, s77
    s_cmp_eq_u32 s60, s82
    s_cselect_b32 s77, 2, s77
    s_cmp_eq_u32 s60, s83
    s_cselect_b32 s77, 3, s77
    s_cmp_eq_u32 s60, s84
    s_cselect_b32 s77, 4, s77
    s_cmp_eq_u32 s60, s85
    s_cselect_b32 s77, 5, s77
    s_cmp_eq_u32 s60, s86
    s_cselect_b32 s77, 6, s77
    s_cmp_eq_u32 s60, s87
    s_cselect_b32 s77, 7, s77
    s_cmp_lt_i32 s77, 0
    s_cbranch_scc1 Lpush_51
    s_cmp_lg_u32 s57, 0
    s_cbranch_scc1 Lpush_51
    s_add_u32 s61, s20, 7
    v_mov_b32 v164, v157
    v_mov_b32 v165, v159
    v_mov_b32 v166, s61
    v_mov_b32 v167, s61
    s_waitcnt lgkmcnt(0)
    buffer_store_dwordx4 v[244:247], v15, s[4:7], s31 offen sc1
    buffer_store_dword v248, v252, s[4:7], s31 offen sc1
    buffer_store_dwordx4 v[228:231], v15, s[4:7], s31 offen offset:1280 sc1
    buffer_store_dword v232, v252, s[4:7], s31 offen offset:1280 sc1
    s_waitcnt vmcnt(0)
    s_mov_b64 exec, 1
    buffer_store_dwordx4 v[164:167], v15, s[4:7], s31 offen offset:2560 sc1
    s_mov_b64 exec, -1
    s_nop 0
Lpush_51:
    s_endpgm
L_roleC:
    v_mov_b32 v252, 0
    buffer_load_dword v252, v252, s[4:7], 0 offen
    s_and_b32 s61, s2, 7
    s_sub_u32 s60, s2, 256
    s_lshr_b32 s60, s60, 3
    s_mov_b32 s84, s46
    s_and_b32 s85, s47, 0xffff
    s_mov_b32 s86, 2211840
    s_mov_b32 s87, 0x00020000
    v_lshrrev_b32 v224, 2, v0
    v_and_b32 v225, 3, v0
    v_min_u32 v224, 22, v224
    s_mul_i32 s64, s60, 23
    v_add_u32 v224, s64, v224
    s_mul_i32 s63, s61, 7
    s_sub_u32 s63, s63, 1
    s_max_i32 s63, s63, 0
    s_lshl_b32 s63, s63, 6
    s_and_b32 s63, s63, -128
    v_lshl_add_u32 v225, v225, 7, s63
    s_movk_i32 s64, 3456
    v_mad_u32_u24 v225, v224, s64, v225
    buffer_load_dword v227, v225, s[84:87], 0 offen
    v_lshrrev_b32 v224, 1, v0
    v_and_b32 v225, 1, v0
    v_min_u32 v224, 59, v224
    s_mul_i32 s64, s60, 60
    v_add_u32 v224, s64, v224
    s_mul_i32 s63, s61, 3
    s_lshl_b32 s62, s61, 1
    s_add_u32 s62, s62, 3
    s_min_u32 s63, s63, s62
    s_lshl_b32 s63, s63, 6
    s_and_b32 s63, s63, -128
    v_lshl_add_u32 v225, v225, 7, s63
    s_movk_i32 s64, 1280
    v_mad_u32_u24 v225, v224, s64, v225
    s_mov_b32 s84, s50
    s_and_b32 s85, s51, 0xffff
    buffer_load_dword v227, v225, s[84:87], 0 offen
    s_sub_u32 s60, s2, 256
    s_and_b32 s61, s60, 7
    s_lshr_b32 s62, s60, 3
    s_lshr_b32 s63, s62, 2
    s_lshl_b32 s63, s63, 5
    s_lshl_b32 s61, s61, 2
    s_and_b32 s62, s62, 3
    s_add_u32 s22, s63, s61
    s_add_u32 s22, s22, s62
    s_and_b32 s23, s2, 15
    s_cmp_eq_u32 s23, 0
    s_cselect_b32 s29, 10, 9
    s_and_b32 s24, s2, 15
    s_lshl_b32 s24, s24, 10
    v_and_b32 v160, 15, v1
    v_lshrrev_b32 v161, 4, v1
    s_and_b32 s70, s21, 1
    s_lshl_b32 s70, s70, 4
    s_lshr_b32 s61, s21, 1
    v_lshrrev_b32 v2, 1, v0
    v_and_b32 v6, 1, v0
    s_lshl_b32 s62, s22, 1
    v_add_u32 v3, s62, v6
    v_min_u32 v3, 320, v3
    v_sub_u32 v4, 640, v3
    v_cmp_ne_u32 vcc, 0, v3
    s_nop 1
    v_cndmask_b32 v4, 0, v4, vcc
    v_add_u32 v5, 7, v4
    v_cmp_lt_u32 vcc, 320, v4
    s_nop 1
    v_cndmask_b32 v4, v4, v5, vcc
    v_mul_u32_u24 v5, 10368, v2
    v_mul_u32_u24 v6, 8256, v6
    v_lshl_add_u32 v6, v2, 4, v6
    v_lshl_add_u32 v2, v3, 4, v5
    v_lshl_add_u32 v3, v4, 4, v5
    s_mul_i32 s63, s61, 8256
    v_lshlrev_b32 v7, 10, v161
    v_lshl_add_u32 v7, v160, 4, v7
    v_add_u32 v7, s63, v7
    s_add_u32 s62, s62, s61
    s_lshl_b32 s62, s62, 12
    v_lshl_add_u32 v8, v161, 6, v160
    v_add_u32 v8, s70, v8
    v_lshl_add_u32 v8, v8, 4, s62
    s_lshr_b32 s62, s62, 6
    s_add_u32 s62, s62, 1318960
    v_lshlrev_b32 v9, 4, v161
    v_sub_u32 v9, s62, v9
    s_waitcnt vmcnt(2)
    v_readfirstlane_b32 s20, v252
    s_nop 0
    s_add_u32 s20, s20, 0x9e3779b9
    s_sub_u32 s60, s2, 256
    s_lshl_b32 s61, s21, 4
    s_or_b32 s60, s60, s61
    s_cmp_ge_u32 s60, 16
    s_cbranch_scc1 Lci_52
    s_add_u32 s60, s23, 0
    s_lshl_b32 s60, s60, 7
    s_add_u32 s60, s60, 1015808
    s_add_u32 s61, s20, 0
    v_mov_b32 v248, 0
    v_mov_b32 v249, s61
    v_mov_b32 v250, 0
    s_mov_b64 exec, 1
    buffer_store_dwordx2 v[248:249], v250, s[4:7], s60 offen sc1
    s_mov_b64 exec, -1
    s_add_u32 s60, s23, 16
    s_lshl_b32 s60, s60, 7
    s_add_u32 s60, s60, 1015808
    s_add_u32 s61, s20, 1
    v_mov_b32 v248, 0
    v_mov_b32 v249, s61
    v_mov_b32 v250, 0
    s_mov_b64 exec, 1
    buffer_store_dwordx2 v[248:249], v250, s[4:7], s60 offen sc1
    s_mov_b64 exec, -1
    s_add_u32 s60, s23, 32
    s_lshl_b32 s60, s60, 7
    s_add_u32 s60, s60, 1015808
    s_add_u32 s61, s20, 2
    v_mov_b32 v248, 0
    v_mov_b32 v249, s61
    v_mov_b32 v250, 0
    s_mov_b64 exec, 1
    buffer_store_dwordx2 v[248:249], v250, s[4:7], s60 offen sc1
    s_mov_b64 exec, -1
    s_add_u32 s60, s23, 48
    s_lshl_b32 s60, s60, 7
    s_add_u32 s60, s60, 1015808
    s_add_u32 s61, s20, 3
    v_mov_b32 v248, 0
    v_mov_b32 v249, s61
    v_mov_b32 v250, 0
    s_mov_b64 exec, 1
    buffer_store_dwordx2 v[248:249], v250, s[4:7], s60 offen sc1
    s_mov_b64 exec, -1
Lci_52:
    v_mov_b32 v240, -1
    v_mov_b32 v241, -1
    v_mov_b32 v242, -1
    v_mov_b32 v243, -1
    s_mov_b32 s63, 6553600
    buffer_store_dwordx4 v[240:243], v8, s[4:7], s63 offen sc1
    buffer_store_dwordx4 v[240:243], v8, s[4:7], s63 offen offset:512 sc1
    s_bitcmp1_b32 s21, 0
    s_nop 0
    s_cbranch_scc1 Lym_53
    s_mov_b32 exec_lo, 0x10001
    s_mov_b32 exec_hi, 0x10001
    buffer_store_dwordx4 v[240:243], v9, s[4:7], s63 offen sc1
    s_mov_b64 exec, -1
    s_nop 0
Lym_53:
    v_add_u32 v162, s70, v160
    v_cvt_f32_u32 v162, v162
    v_cvt_f32_u32 v163, v161
    v_mul_f32 v166, 0x3d000000, v162
    v_mul_f32 v165, v166, v163
    v_mul_f32 v165, 0x41000000, v165
    v_fmamk_f32 v164, v166, 0x00000000, v165
    v_cos_f32 v167, v164
    v_sin_f32 v168, v164
    v_add_f32 v164, v164, v166
    v_cos_f32 v169, v164
    v_sin_f32 v170, v164
    s_nop 0
    v_sub_f32 v171, v167, v170
    v_add_f32 v172, v168, v169
    v_cvt_pk_f16_f32 v16, v171, v172
    v_cvt_pk_f16_f32 v20, -v172, v171
    v_add_f32 v171, v167, v170
    v_sub_f32 v172, v169, v168
    v_cvt_pk_f16_f32 v24, v171, v172
    v_cvt_pk_f16_f32 v28, v172, -v171
    v_fmamk_f32 v164, v166, 0x40000000, v165
    v_cos_f32 v167, v164
    v_sin_f32 v168, v164
    v_add_f32 v164, v164, v166
    v_cos_f32 v169, v164
    v_sin_f32 v170, v164
    s_nop 0
    v_sub_f32 v171, v167, v170
    v_add_f32 v172, v168, v169
    v_cvt_pk_f16_f32 v17, v171, v172
    v_cvt_pk_f16_f32 v21, -v172, v171
    v_add_f32 v171, v167, v170
    v_sub_f32 v172, v169, v168
    v_cvt_pk_f16_f32 v25, v171, v172
    v_cvt_pk_f16_f32 v29, v172, -v171
    v_fmamk_f32 v164, v166, 0x40800000, v165
    v_cos_f32 v167, v164
    v_sin_f32 v168, v164
    v_add_f32 v164, v164, v166
    v_cos_f32 v169, v164
    v_sin_f32 v170, v164
    s_nop 0
    v_sub_f32 v171, v167, v170
    v_add_f32 v172, v168, v169
    v_cvt_pk_f16_f32 v18, v171, v172
    v_cvt_pk_f16_f32 v22, -v172, v171
    v_add_f32 v171, v167, v170
    v_sub_f32 v172, v169, v168
    v_cvt_pk_f16_f32 v26, v171, v172
    v_cvt_pk_f16_f32 v30, v172, -v171
    v_fmamk_f32 v164, v166, 0x40c00000, v165
    v_cos_f32 v167, v164
    v_sin_f32 v168, v164
    v_add_f32 v164, v164, v166
    v_cos_f32 v169, v164
    v_sin_f32 v170, v164
    s_nop 0
    v_sub_f32 v171, v167, v170
    v_add_f32 v172, v168, v169
    v_cvt_pk_f16_f32 v19, v171, v172
    v_cvt_pk_f16_f32 v23, -v172, v171
    v_add_f32 v171, v167, v170
    v_sub_f32 v172, v169, v168
    v_cvt_pk_f16_f32 v27, v171, v172
    v_cvt_pk_f16_f32 v31, v172, -v171
    v_mul_f32 v166, 0x3a000000, v162
    v_mul_f32 v165, v166, v163
    v_mul_f32 v165, 4.0, v165
    v_fmamk_f32 v164, v166, 0x00000000, v165
    v_cos_f32 v167, v164
    v_sin_f32 v168, v164
    v_mul_f32 v32, 0x3c800000, v167
    v_mul_f32 v48, 0x3c800000, v168
    v_fmamk_f32 v164, v166, 0x3f800000, v165
    v_cos_f32 v167, v164
    v_sin_f32 v168, v164
    v_mul_f32 v33, 0x3c800000, v167
    v_mul_f32 v49, 0x3c800000, v168
    v_fmamk_f32 v164, v166, 0x40000000, v165
    v_cos_f32 v167, v164
    v_sin_f32 v168, v164
    v_mul_f32 v34, 0x3c800000, v167
    v_mul_f32 v50, 0x3c800000, v168
    v_fmamk_f32 v164, v166, 0x40400000, v165
    v_cos_f32 v167, v164
    v_sin_f32 v168, v164
    v_mul_f32 v35, 0x3c800000, v167
    v_mul_f32 v51, 0x3c800000, v168
    v_fmamk_f32 v164, v166, 0x41800000, v165
    v_cos_f32 v167, v164
    v_sin_f32 v168, v164
    v_mul_f32 v36, 0x3c800000, v167
    v_mul_f32 v52, 0x3c800000, v168
    v_fmamk_f32 v164, v166, 0x41880000, v165
    v_cos_f32 v167, v164
    v_sin_f32 v168, v164
    v_mul_f32 v37, 0x3c800000, v167
    v_mul_f32 v53, 0x3c800000, v168
    v_fmamk_f32 v164, v166, 0x41900000, v165
    v_cos_f32 v167, v164
    v_sin_f32 v168, v164
    v_mul_f32 v38, 0x3c800000, v167
    v_mul_f32 v54, 0x3c800000, v168
    v_fmamk_f32 v164, v166, 0x41980000, v165
    v_cos_f32 v167, v164
    v_sin_f32 v168, v164
    v_mul_f32 v39, 0x3c800000, v167
    v_mul_f32 v55, 0x3c800000, v168
    v_fmamk_f32 v164, v166, 0x42000000, v165
    v_cos_f32 v167, v164
    v_sin_f32 v168, v164
    v_mul_f32 v40, 0x3c800000, v167
    v_mul_f32 v56, 0x3c800000, v168
    v_fmamk_f32 v164, v166, 0x42040000, v165
    v_cos_f32 v167, v164
    v_sin_f32 v168, v164
    v_mul_f32 v41, 0x3c800000, v167
    v_mul_f32 v57, 0x3c800000, v168
    v_fmamk_f32 v164, v166, 0x42080000, v165
    v_cos_f32 v167, v164
    v_sin_f32 v168, v164
    v_mul_f32 v42, 0x3c800000, v167
    v_mul_f32 v58, 0x3c800000, v168
    v_fmamk_f32 v164, v166, 0x420c0000, v165
    v_cos_f32 v167, v164
    v_sin_f32 v168, v164
    v_mul_f32 v43, 0x3c800000, v167
    v_mul_f32 v59, 0x3c800000, v168
    v_fmamk_f32 v164, v166, 0x42400000, v165
    v_cos_f32 v167, v164
    v_sin_f32 v168, v164
    v_mul_f32 v44, 0x3c800000, v167
    v_mul_f32 v60, 0x3c800000, v168
    v_fmamk_f32 v164, v166, 0x42440000, v165
    v_cos_f32 v167, v164
    v_sin_f32 v168, v164
    v_mul_f32 v45, 0x3c800000, v167
    v_mul_f32 v61, 0x3c800000, v168
    v_fmamk_f32 v164, v166, 0x42480000, v165
    v_cos_f32 v167, v164
    v_sin_f32 v168, v164
    v_mul_f32 v46, 0x3c800000, v167
    v_mul_f32 v62, 0x3c800000, v168
    v_fmamk_f32 v164, v166, 0x424c0000, v165
    v_cos_f32 v167, v164
    v_sin_f32 v168, v164
    v_mul_f32 v47, 0x3c800000, v167
    v_mul_f32 v63, 0x3c800000, v168
    v_lshrrev_b32 v171, 2, v160
    v_lshlrev_b32 v171, 4, v171
    v_and_b32 v172, 3, v160
    v_lshl_add_u32 v171, v172, 1, v171
    s_lshr_b32 s60, s70, 1
    s_lshr_b32 s61, s21, 1
    s_add_u32 s60, s60, s61
    v_add_u32 v171, s60, v171
    v_cvt_f32_u32 v171, v171
    v_mul_f32 v166, 0x3c800000, v171
    v_mul_f32 v165, v166, v163
    v_mul_f32 v165, 4.0, v165
    s_lshl_b32 s60, s21, 12
    s_add_u32 s60, s60, 24576
    v_lshl_add_u32 v172, v1, 4, s60
    v_fmamk_f32 v164, v166, 0x00000000, v165
    v_cos_f32 v167, v164
    v_sin_f32 v168, v164
    s_nop 0
    v_cvt_pk_f16_f32 v128, v167, v168
    v_fmamk_f32 v164, v166, 0x3f800000, v165
    v_cos_f32 v167, v164
    v_sin_f32 v168, v164
    s_nop 0
    v_cvt_pk_f16_f32 v129, v167, v168
    v_fmamk_f32 v164, v166, 0x40000000, v165
    v_cos_f32 v167, v164
    v_sin_f32 v168, v164
    s_nop 0
    v_cvt_pk_f16_f32 v130, v167, v168
    v_fmamk_f32 v164, v166, 0x40400000, v165
    v_cos_f32 v167, v164
    v_sin_f32 v168, v164
    s_nop 0
    v_cvt_pk_f16_f32 v131, v167, v168
    ds_write_b128 v172, v[128:131] offset:0
    v_fmamk_f32 v164, v166, 0x41800000, v165
    v_cos_f32 v167, v164
    v_sin_f32 v168, v164
    s_nop 0
    v_cvt_pk_f16_f32 v132, v167, v168
    v_fmamk_f32 v164, v166, 0x41880000, v165
    v_cos_f32 v167, v164
    v_sin_f32 v168, v164
    s_nop 0
    v_cvt_pk_f16_f32 v133, v167, v168
    v_fmamk_f32 v164, v166, 0x41900000, v165
    v_cos_f32 v167, v164
    v_sin_f32 v168, v164
    s_nop 0
    v_cvt_pk_f16_f32 v134, v167, v168
    v_fmamk_f32 v164, v166, 0x41980000, v165
    v_cos_f32 v167, v164
    v_sin_f32 v168, v164
    s_nop 0
    v_cvt_pk_f16_f32 v135, v167, v168
    ds_write_b128 v172, v[132:135] offset:1024
    v_fmamk_f32 v164, v166, 0x42000000, v165
    v_cos_f32 v167, v164
    v_sin_f32 v168, v164
    s_nop 0
    v_cvt_pk_f16_f32 v136, v167, v168
    v_fmamk_f32 v164, v166, 0x42040000, v165
    v_cos_f32 v167, v164
    v_sin_f32 v168, v164
    s_nop 0
    v_cvt_pk_f16_f32 v137, v167, v168
    v_fmamk_f32 v164, v166, 0x42080000, v165
    v_cos_f32 v167, v164
    v_sin_f32 v168, v164
    s_nop 0
    v_cvt_pk_f16_f32 v138, v167, v168
    v_fmamk_f32 v164, v166, 0x420c0000, v165
    v_cos_f32 v167, v164
    v_sin_f32 v168, v164
    s_nop 0
    v_cvt_pk_f16_f32 v139, v167, v168
    ds_write_b128 v172, v[136:139] offset:2048
    v_fmamk_f32 v164, v166, 0x42400000, v165
    v_cos_f32 v167, v164
    v_sin_f32 v168, v164
    s_nop 0
    v_cvt_pk_f16_f32 v140, v167, v168
    v_fmamk_f32 v164, v166, 0x42440000, v165
    v_cos_f32 v167, v164
    v_sin_f32 v168, v164
    s_nop 0
    v_cvt_pk_f16_f32 v141, v167, v168
    v_fmamk_f32 v164, v166, 0x42480000, v165
    v_cos_f32 v167, v164
    v_sin_f32 v168, v164
    s_nop 0
    v_cvt_pk_f16_f32 v142, v167, v168
    v_fmamk_f32 v164, v166, 0x424c0000, v165
    v_cos_f32 v167, v164
    v_sin_f32 v168, v164
    s_nop 0
    v_cvt_pk_f16_f32 v143, v167, v168
    ds_write_b128 v172, v[140:143] offset:3072
    v_lshlrev_b32 v172, 4, v1
    s_waitcnt lgkmcnt(0)
    s_barrier
    ds_read_b128 v[64:67], v172 offset:24576
    ds_read_b128 v[68:71], v172 offset:25600
    ds_read_b128 v[72:75], v172 offset:26624
    ds_read_b128 v[76:79], v172 offset:27648
    ds_read_b128 v[80:83], v172 offset:28672
    ds_read_b128 v[84:87], v172 offset:29696
    ds_read_b128 v[88:91], v172 offset:30720
    ds_read_b128 v[92:95], v172 offset:31744
    s_waitcnt lgkmcnt(0)
    ds_read_b128 v[96:99], v172 offset:32768
    ds_read_b128 v[100:103], v172 offset:33792
    ds_read_b128 v[104:107], v172 offset:34816
    ds_read_b128 v[108:111], v172 offset:35840
    ds_read_b128 v[112:115], v172 offset:36864
    ds_read_b128 v[116:119], v172 offset:37888
    ds_read_b128 v[120:123], v172 offset:38912
    ds_read_b128 v[124:127], v172 offset:39936
    s_waitcnt vmcnt(0)
    s_setprio 3
    s_mov_b32 s25, 0
    s_mov_b32 s26, 1048576
    s_mov_b32 s28, 6553600
L_Cloop:
    s_add_u32 s27, s26, 1327104
    s_cmp_lg_u32 s21, 0
    s_cbranch_scc1 Lpolld_55
    s_mul_i32 s60, s25, 16384
    s_add_u32 s60, s60, s24
    s_add_u32 s60, s60, 4096
    s_add_u32 s61, s20, s25
    v_and_b32 v249, 15, v1
    v_lshlrev_b32 v249, 6, v249
    s_mov_b32 s62, 40000
    s_nop 0
Lpoll_54:
    buffer_load_dword v248, v249, s[4:7], s60 offen sc1
    s_waitcnt vmcnt(0)
    v_cmp_ne_u32 vcc, s61, v248
    s_nop 4
    s_cbranch_vccz Lpolld_55
    s_sub_u32 s62, s62, 1
    s_cmp_lg_u32 s62, 0
    s_cbranch_scc1 Lpoll_54
Lpolld_55:
    s_barrier
    s_add_u32 s30, s25, 1
    s_cmp_lg_u32 s21, 1
    s_cbranch_scc1 Larr_58
    s_lshl_b32 s66, s30, 4
    s_add_u32 s66, s66, s23
    s_lshl_b32 s66, s66, 7
    s_add_u32 s66, s66, 1015808
    v_mov_b32 v240, 1
    v_mov_b32 v241, 0
    v_mov_b32 v242, 0
    s_mov_b64 exec, 1
    buffer_atomic_add_x2 v[240:241], v242, s[4:7], s66 offen sc0
    s_mov_b64 exec, -1
Larr_58:
    s_mov_b32 s62, 40000
Lcw_56:
    buffer_load_dwordx4 v[160:163], v2, s[4:7], s26 offen sc1
    buffer_load_dwordx4 v[164:167], v2, s[4:7], s27 offen sc1
    buffer_load_dwordx4 v[168:171], v3, s[4:7], s26 offen sc1
    buffer_load_dwordx4 v[172:175], v3, s[4:7], s27 offen sc1
    s_mov_b32 s31, 0
    s_waitcnt vmcnt(3)
    ds_write_b128 v6, v[160:163] offset:0
    s_waitcnt vmcnt(2)
    ds_write_b128 v6, v[164:167] offset:2048
    s_waitcnt vmcnt(1)
    ds_write_b128 v6, v[168:171] offset:4096
    s_waitcnt vmcnt(0)
    ds_write_b128 v6, v[172:175] offset:6144
    v_max3_u32 v248, v160, v161, v162
    v_max3_u32 v248, v248, v163, v164
    v_max3_u32 v248, v248, v165, v166
    v_max3_u32 v248, v248, v167, v168
    v_max3_u32 v248, v248, v169, v170
    v_max3_u32 v248, v248, v171, v172
    v_max3_u32 v248, v248, v173, v174
    v_max_u32 v248, v248, v175
    v_cmp_eq_u32 vcc, -1, v248
    s_nop 4
    s_cbranch_vccz Lcwd_57
    s_sleep 2
    s_sub_u32 s62, s62, 1
    s_cmp_lg_u32 s62, 0
    s_cbranch_scc1 Lcw_56
Lcwd_57:
    s_waitcnt lgkmcnt(0)
    s_barrier
    ds_read_b128 v[128:131], v7 offset:0
    ds_read_b128 v[132:135], v7 offset:4096
    ds_read_b128 v[136:139], v7 offset:256
    ds_read_b128 v[140:143], v7 offset:4352
    ds_read_b128 v[144:147], v7 offset:512
    ds_read_b128 v[148:151], v7 offset:4608
    ds_read_b128 v[152:155], v7 offset:768
    ds_read_b128 v[156:159], v7 offset:4864
    s_cmp_lg_u32 s21, 1
    s_cbranch_scc1 Lsig_59
    s_mul_i32 s67, s30, 16384
    s_lshl_b32 s68, s23, 6
    s_add_u32 s67, s67, s68
    s_add_u32 s67, s67, 4096
    s_add_u32 s68, s20, s30
    v_lshlrev_b32 v243, 10, v1
    v_mov_b32 v244, s68
    s_mov_b32 s69, 40000
    s_waitcnt vmcnt(0)
    s_branch Lsigc_61
Lsiga_60:
    s_sub_u32 s69, s69, 1
    s_cmp_eq_u32 s69, 0
    s_cbranch_scc1 Lsig_59
    v_mov_b32 v240, 1
    v_mov_b32 v241, 0
    v_mov_b32 v242, 0
    s_mov_b64 exec, 1
    buffer_atomic_add_x2 v[240:241], v242, s[4:7], s66 offen sc0
    s_mov_b64 exec, -1
    s_waitcnt vmcnt(0)
Lsigc_61:
    v_readfirstlane_b32 s65, v241
    v_readfirstlane_b32 s64, v240
    s_cmp_lg_u32 s65, s68
    s_nop 3
    s_cbranch_scc1 Lsiga_60
    s_cmp_lg_u32 s64, s29
    s_cbranch_scc1 Lsig_59
    s_mov_b32 exec_lo, 0xffff
    s_mov_b32 exec_hi, 0x0
    buffer_store_dword v244, v243, s[4:7], s67 offen sc1
    s_mov_b64 exec, -1
Lsig_59:
    s_waitcnt lgkmcnt(7)
    v_mfma_f32_16x16x32_f16 v[176:179], v[128:131], v[16:19], 0
    v_mfma_f32_16x16x32_f16 v[192:195], v[128:131], v[20:23], 0
    s_waitcnt lgkmcnt(6)
    v_mfma_f32_16x16x32_f16 v[176:179], v[132:135], v[24:27], v[176:179]
    v_mfma_f32_16x16x32_f16 v[192:195], v[132:135], v[28:31], v[192:195]
    s_waitcnt lgkmcnt(5)
    v_mfma_f32_16x16x32_f16 v[180:183], v[136:139], v[16:19], 0
    v_mfma_f32_16x16x32_f16 v[196:199], v[136:139], v[20:23], 0
    s_waitcnt lgkmcnt(4)
    v_mfma_f32_16x16x32_f16 v[180:183], v[140:143], v[24:27], v[180:183]
    v_mfma_f32_16x16x32_f16 v[196:199], v[140:143], v[28:31], v[196:199]
    s_waitcnt lgkmcnt(3)
    v_mfma_f32_16x16x32_f16 v[184:187], v[144:147], v[16:19], 0
    v_mfma_f32_16x16x32_f16 v[200:203], v[144:147], v[20:23], 0
    s_waitcnt lgkmcnt(2)
    v_mfma_f32_16x16x32_f16 v[184:187], v[148:151], v[24:27], v[184:187]
    v_mfma_f32_16x16x32_f16 v[200:203], v[148:151], v[28:31], v[200:203]
    s_waitcnt lgkmcnt(1)
    v_mfma_f32_16x16x32_f16 v[188:191], v[152:155], v[16:19], 0
    v_mfma_f32_16x16x32_f16 v[204:207], v[152:155], v[20:23], 0
    s_waitcnt lgkmcnt(0)
    v_mfma_f32_16x16x32_f16 v[188:191], v[156:159], v[24:27], v[188:191]
    v_mfma_f32_16x16x32_f16 v[204:207], v[156:159], v[28:31], v[204:207]
    s_add_u32 s25, s25, 1
    v_pk_mul_f32 v[160:161], v[176:177], v[32:33]
    v_pk_mul_f32 v[162:163], v[192:193], v[32:33]
    v_pk_fma_f32 v[160:161], v[192:193], v[48:49], v[160:161]
    v_pk_fma_f32 v[162:163], v[176:177], v[48:49], v[162:163] neg_lo:[1,0,0] neg_hi:[1,0,0]
    v_cvt_pk_f16_f32 v208, v160, v162
    v_cvt_pk_f16_f32 v209, v161, v163
    v_pk_mul_f32 v[164:165], v[178:179], v[34:35]
    v_pk_mul_f32 v[166:167], v[194:195], v[34:35]
    v_pk_fma_f32 v[164:165], v[194:195], v[50:51], v[164:165]
    v_pk_fma_f32 v[166:167], v[178:179], v[50:51], v[166:167] neg_lo:[1,0,0] neg_hi:[1,0,0]
    v_cvt_pk_f16_f32 v210, v164, v166
    v_cvt_pk_f16_f32 v211, v165, v167
    s_nop 1
    v_mfma_f32_16x16x32_f16 v[224:227], v[64:67], v[208:211], 0
    v_mfma_f32_16x16x32_f16 v[228:231], v[80:83], v[208:211], 0
    v_mfma_f32_16x16x32_f16 v[232:235], v[96:99], v[208:211], 0
    v_mfma_f32_16x16x32_f16 v[236:239], v[112:115], v[208:211], 0
    v_pk_mul_f32 v[160:161], v[180:181], v[36:37]
    v_pk_mul_f32 v[162:163], v[196:197], v[36:37]
    v_pk_fma_f32 v[160:161], v[196:197], v[52:53], v[160:161]
    v_pk_fma_f32 v[162:163], v[180:181], v[52:53], v[162:163] neg_lo:[1,0,0] neg_hi:[1,0,0]
    v_cvt_pk_f16_f32 v212, v160, v162
    v_cvt_pk_f16_f32 v213, v161, v163
    v_pk_mul_f32 v[164:165], v[182:183], v[38:39]
    v_pk_mul_f32 v[166:167], v[198:199], v[38:39]
    v_pk_fma_f32 v[164:165], v[198:199], v[54:55], v[164:165]
    v_pk_fma_f32 v[166:167], v[182:183], v[54:55], v[166:167] neg_lo:[1,0,0] neg_hi:[1,0,0]
    v_cvt_pk_f16_f32 v214, v164, v166
    v_cvt_pk_f16_f32 v215, v165, v167
    s_nop 1
    v_mfma_f32_16x16x32_f16 v[224:227], v[68:71], v[212:215], v[224:227]
    v_mfma_f32_16x16x32_f16 v[228:231], v[84:87], v[212:215], v[228:231]
    v_mfma_f32_16x16x32_f16 v[232:235], v[100:103], v[212:215], v[232:235]
    v_mfma_f32_16x16x32_f16 v[236:239], v[116:119], v[212:215], v[236:239]
    v_pk_mul_f32 v[160:161], v[184:185], v[40:41]
    v_pk_mul_f32 v[162:163], v[200:201], v[40:41]
    v_pk_fma_f32 v[160:161], v[200:201], v[56:57], v[160:161]
    v_pk_fma_f32 v[162:163], v[184:185], v[56:57], v[162:163] neg_lo:[1,0,0] neg_hi:[1,0,0]
    v_cvt_pk_f16_f32 v216, v160, v162
    v_cvt_pk_f16_f32 v217, v161, v163
    v_pk_mul_f32 v[164:165], v[186:187], v[42:43]
    v_pk_mul_f32 v[166:167], v[202:203], v[42:43]
    v_pk_fma_f32 v[164:165], v[202:203], v[58:59], v[164:165]
    v_pk_fma_f32 v[166:167], v[186:187], v[58:59], v[166:167] neg_lo:[1,0,0] neg_hi:[1,0,0]
    v_cvt_pk_f16_f32 v218, v164, v166
    v_cvt_pk_f16_f32 v219, v165, v167
    s_nop 1
    v_mfma_f32_16x16x32_f16 v[224:227], v[72:75], v[216:219], v[224:227]
    v_mfma_f32_16x16x32_f16 v[228:231], v[88:91], v[216:219], v[228:231]
    v_mfma_f32_16x16x32_f16 v[232:235], v[104:107], v[216:219], v[232:235]
    v_mfma_f32_16x16x32_f16 v[236:239], v[120:123], v[216:219], v[236:239]
    v_pk_mul_f32 v[160:161], v[188:189], v[44:45]
    v_pk_mul_f32 v[162:163], v[204:205], v[44:45]
    v_pk_fma_f32 v[160:161], v[204:205], v[60:61], v[160:161]
    v_pk_fma_f32 v[162:163], v[188:189], v[60:61], v[162:163] neg_lo:[1,0,0] neg_hi:[1,0,0]
    v_cvt_pk_f16_f32 v220, v160, v162
    v_cvt_pk_f16_f32 v221, v161, v163
    v_pk_mul_f32 v[164:165], v[190:191], v[46:47]
    v_pk_mul_f32 v[166:167], v[206:207], v[46:47]
    v_pk_fma_f32 v[164:165], v[206:207], v[62:63], v[164:165]
    v_pk_fma_f32 v[166:167], v[190:191], v[62:63], v[166:167] neg_lo:[1,0,0] neg_hi:[1,0,0]
    v_cvt_pk_f16_f32 v222, v164, v166
    v_cvt_pk_f16_f32 v223, v165, v167
    s_nop 1
    v_mfma_f32_16x16x32_f16 v[224:227], v[76:79], v[220:223], v[224:227]
    v_mfma_f32_16x16x32_f16 v[228:231], v[92:95], v[220:223], v[228:231]
    v_mfma_f32_16x16x32_f16 v[232:235], v[108:111], v[220:223], v[232:235]
    v_mfma_f32_16x16x32_f16 v[236:239], v[124:127], v[220:223], v[236:239]
    s_nop 4
    v_cvt_pk_f16_f32 v240, v224, v225
    v_cvt_pk_f16_f32 v241, v226, v227
    v_cvt_pk_f16_f32 v242, v228, v229
    v_cvt_pk_f16_f32 v243, v230, v231
    v_cvt_pk_f16_f32 v244, v232, v233
    v_cvt_pk_f16_f32 v245, v234, v235
    v_cvt_pk_f16_f32 v246, v236, v237
    v_cvt_pk_f16_f32 v247, v238, v239
    buffer_store_dwordx4 v[240:243], v8, s[4:7], s28 offen sc1
    buffer_store_dwordx4 v[244:247], v8, s[4:7], s28 offen offset:512 sc1
    s_bitcmp1_b32 s21, 0
    s_nop 0
    s_cbranch_scc1 Lym_62
    v_readlane_b32 s60, v240, 16
    v_readlane_b32 s61, v240, 32
    v_readlane_b32 s62, v240, 48
    v_readlane_b32 s63, v240, 0
    s_nop 0
    v_writelane_b32 v212, s60, 0
    v_writelane_b32 v212, s61, 16
    v_writelane_b32 v212, s62, 32
    v_writelane_b32 v212, s63, 48
    v_alignbit_b32 v208, v241, v240, 16
    v_alignbit_b32 v209, v242, v241, 16
    v_alignbit_b32 v210, v243, v242, 16
    v_alignbit_b32 v211, v212, v243, 16
    s_mov_b32 exec_lo, 0x10001
    s_mov_b32 exec_hi, 0x10001
    buffer_store_dwordx4 v[208:211], v9, s[4:7], s28 offen sc1
    s_mov_b64 exec, -1
    s_nop 0
Lym_62:
    s_add_u32 s25, s25, 1
    s_add_u32 s26, s26, 2686976
    s_add_u32 s28, s28, 1441792
    s_cmp_ge_u32 s25, 4
    s_cbranch_scc1 L_end
    s_waitcnt vmcnt(0)
    v_mov_b32 v240, -1
    v_mov_b32 v241, -1
    v_mov_b32 v242, -1
    v_mov_b32 v243, -1
    buffer_store_dwordx4 v[240:243], v8, s[4:7], s28 offen sc1
    buffer_store_dwordx4 v[240:243], v8, s[4:7], s28 offen offset:512 sc1
    s_bitcmp1_b32 s21, 0
    s_nop 0
    s_cbranch_scc1 Lym_63
    s_mov_b32 exec_lo, 0x10001
    s_mov_b32 exec_hi, 0x10001
    buffer_store_dwordx4 v[240:243], v9, s[4:7], s28 offen sc1
    s_mov_b64 exec, -1
    s_nop 0
Lym_63:
    s_waitcnt vmcnt(0)
    s_branch L_Cloop
L_roleFa:
    v_mov_b32 v216, 0
    buffer_load_dword v216, v216, s[4:7], 0 offen
    s_and_b32 s61, s2, 7
    s_sub_u32 s60, s2, 256
    s_lshr_b32 s60, s60, 3
    s_mov_b32 s84, s46
    s_and_b32 s85, s47, 0xffff
    s_mov_b32 s86, 2211840
    s_mov_b32 s87, 0x00020000
    v_lshrrev_b32 v220, 2, v0
    v_and_b32 v221, 3, v0
    v_min_u32 v220, 22, v220
    s_mul_i32 s64, s60, 23
    v_add_u32 v220, s64, v220
    s_mul_i32 s63, s61, 7
    s_sub_u32 s63, s63, 1
    s_max_i32 s63, s63, 0
    s_lshl_b32 s63, s63, 6
    s_and_b32 s63, s63, -128
    v_lshl_add_u32 v221, v221, 7, s63
    s_movk_i32 s64, 3456
    v_mad_u32_u24 v221, v220, s64, v221
    buffer_load_dword v223, v221, s[84:87], 0 offen
    v_lshrrev_b32 v220, 1, v0
    v_and_b32 v221, 1, v0
    v_min_u32 v220, 59, v220
    s_mul_i32 s64, s60, 60
    v_add_u32 v220, s64, v220
    s_mul_i32 s63, s61, 3
    s_lshl_b32 s62, s61, 1
    s_add_u32 s62, s62, 3
    s_min_u32 s63, s63, s62
    s_lshl_b32 s63, s63, 6
    s_and_b32 s63, s63, -128
    v_lshl_add_u32 v221, v221, 7, s63
    s_movk_i32 s64, 1280
    v_mad_u32_u24 v221, v220, s64, v221
    s_mov_b32 s84, s50
    s_and_b32 s85, s51, 0xffff
    buffer_load_dword v223, v221, s[84:87], 0 offen
    s_mov_b32 s8, s46
    s_and_b32 s9, s47, 0xffff
    s_mov_b32 s10, 2211840
    s_mov_b32 s11, 0x00020000
    s_mov_b32 s12, s48
    s_and_b32 s13, s49, 0xffff
    s_mov_b32 s14, 2211840
    s_mov_b32 s15, 0x00020000
    s_sub_u32 s60, s2, 416
    s_and_b32 s61, s60, 7
    s_lshr_b32 s60, s60, 3
    s_mul_i32 s22, s61, 7
    s_add_u32 s22, s22, s60
    s_sub_u32 s22, s22, 1
    s_mov_b32 s58, 0x05040100
    s_mov_b32 s59, 0x07060302
    v_and_b32 v208, 15, v1
    v_lshrrev_b32 v209, 4, v1
    s_lshr_b32 s60, s21, 1
    s_mul_i32 s60, s60, 320
    s_and_b32 s61, s21, 1
    s_lshl_b32 s61, s61, 4
    s_add_u32 s60, s60, s61
    s_lshl_b32 s61, s22, 6
    v_lshl_add_u32 v210, v208, 2, s61
    v_add_u32 v5, s60, v209
    v_mul_u32_u24 v5, 3456, v5
    v_add_u32 v5, v5, v210
    v_lshl_add_u32 v6, v209, 2, s60
    v_mul_u32_u24 v6, 3456, v6
    v_add_u32 v6, v6, v210
    s_waitcnt vmcnt(0)
    v_readfirstlane_b32 s20, v216
    s_nop 0
    s_add_u32 s20, s20, 0x9e3779b9
    s_and_b32 s29, s2, 15
    s_lshl_b32 s29, s29, 10
    s_mov_b32 s16, s44
    s_and_b32 s17, s45, 0xffff
    s_mov_b32 s18, 1280
    s_mov_b32 s19, 0x00020000
    v_and_b32 v210, 31, v1
    v_lshrrev_b32 v211, 5, v1
    v_mul_u32_u24 v211, 640, v211
    v_lshl_add_u32 v210, v210, 1, v211
    v_mov_b32 v176, 0
    buffer_load_short_d16_hi v176, v210, s[16:19], 0 offen offset:0
    v_mov_b32 v177, 0
    buffer_load_short_d16_hi v177, v210, s[16:19], 0 offen offset:64
    v_mov_b32 v178, 0
    buffer_load_short_d16_hi v178, v210, s[16:19], 0 offen offset:128
    v_mov_b32 v179, 0
    buffer_load_short_d16_hi v179, v210, s[16:19], 0 offen offset:192
    v_mov_b32 v180, 0
    buffer_load_short_d16_hi v180, v210, s[16:19], 0 offen offset:256
    v_mov_b32 v181, 0
    buffer_load_short_d16_hi v181, v210, s[16:19], 0 offen offset:320
    v_mov_b32 v182, 0
    buffer_load_short_d16_hi v182, v210, s[16:19], 0 offen offset:384
    v_mov_b32 v183, 0
    buffer_load_short_d16_hi v183, v210, s[16:19], 0 offen offset:448
    v_mov_b32 v184, 0
    buffer_load_short_d16_hi v184, v210, s[16:19], 0 offen offset:512
    v_mov_b32 v185, 0
    buffer_load_short_d16_hi v185, v210, s[16:19], 0 offen offset:576
    s_waitcnt vmcnt(0)
    v_pk_mul_f32 v[210:211], v[176:177], v[176:177]
    v_pk_fma_f32 v[210:211], v[178:179], v[178:179], v[210:211]
    v_pk_fma_f32 v[210:211], v[180:181], v[180:181], v[210:211]
    v_pk_fma_f32 v[210:211], v[182:183], v[182:183], v[210:211]
    v_pk_fma_f32 v[210:211], v[184:185], v[184:185], v[210:211]
    v_add_f32 v210, v210, v211
    v_mov_b32 v211, v210
    s_nop 1
    v_permlane32_swap_b32 v210, v211
    v_add_f32 v210, v210, v211
    v_mov_b32 v211, v210
    s_nop 1
    v_permlane16_swap_b32 v210, v211
    v_add_f32 v210, v210, v211
    s_nop 1
    v_add_f32_dpp v210, v210, v210 row_ror:8 row_mask:0xf bank_mask:0xf
    s_nop 1
    v_add_f32_dpp v210, v210, v210 row_ror:4 row_mask:0xf bank_mask:0xf
    s_nop 1
    v_add_f32_dpp v210, v210, v210 row_ror:2 row_mask:0xf bank_mask:0xf
    s_nop 1
    v_add_f32_dpp v210, v210, v210 row_ror:1 row_mask:0xf bank_mask:0xf
    v_sqrt_f32 v210, v210
    s_nop 0
    v_mul_f32 v210, 0x40040000, v210
    v_or_b32 v210, 0x80000000, v210
    s_nop 0
    v_readfirstlane_b32 s36, v210
    s_cmp_lg_u32 s21, 0
    s_nop 3
    s_cbranch_scc1 Lpolld_65
    s_add_u32 s60, s29, 4096
    s_add_u32 s61, s20, 0
    v_and_b32 v213, 15, v1
    v_lshlrev_b32 v213, 6, v213
    s_mov_b32 s62, 40000
    s_nop 0
Lpoll_64:
    buffer_load_dword v212, v213, s[4:7], s60 offen sc1
    s_waitcnt vmcnt(0)
    v_cmp_ne_u32 vcc, s61, v212
    s_nop 4
    s_cbranch_vccz Lpolld_65
    s_sleep 2
    s_sub_u32 s62, s62, 1
    s_cmp_lg_u32 s62, 0
    s_cbranch_scc1 Lpoll_64
Lpolld_65:
    s_barrier
    s_and_b32 s61, s2, 7
    s_sub_u32 s60, s2, 416
    s_lshr_b32 s60, s60, 3
    s_cmp_eq_u32 s61, 0
    s_cselect_b32 s62, 1, 0
    s_sub_u32 s60, s60, s62
    s_min_u32 s60, s60, 8
    s_mul_i32 s63, s61, 7
    s_sub_u32 s63, s63, 1
    s_max_i32 s63, s63, 0
    s_lshl_b32 s63, s63, 6
    s_and_b32 s63, s63, -128
    v_and_b32 v221, 3, v0
    v_lshl_add_u32 v221, v221, 7, s63
    s_mul_i32 s64, s60, 72
    s_movk_i32 s65, 3456
    s_mov_b32 s84, s46
    s_and_b32 s85, s47, 0xffff
    s_mov_b32 s86, 2211840
    s_mov_b32 s87, 0x00020000
    s_mov_b32 s88, s48
    s_and_b32 s89, s49, 0xffff
    s_mov_b32 s90, 2211840
    s_mov_b32 s91, 0x00020000
    v_lshrrev_b32 v220, 2, v0
    v_add_u32 v220, 0, v220
    v_min_u32 v220, 71, v220
    v_add_u32 v220, s64, v220
    v_mad_u32_u24 v220, v220, s65, v221
    buffer_load_dword v223, v220, s[88:91], 0 offen
    v_lshrrev_b32 v220, 2, v0
    v_add_u32 v220, 64, v220
    v_min_u32 v220, 71, v220
    v_add_u32 v220, s64, v220
    v_mad_u32_u24 v220, v220, s65, v221
    s_mov_b32 exec_lo, 0xffffffff
    s_mov_b32 exec_hi, 0x0
    buffer_load_dword v223, v220, s[88:91], 0 offen
    s_mov_b64 exec, -1
    s_mul_i32 s63, s61, 3
    s_lshl_b32 s62, s61, 1
    s_add_u32 s62, s62, 3
    s_min_u32 s63, s63, s62
    s_lshl_b32 s63, s63, 6
    s_and_b32 s63, s63, -128
    v_and_b32 v221, 1, v0
    v_lshl_add_u32 v221, v221, 7, s63
    s_mul_i32 s64, s60, 192
    s_movk_i32 s65, 1280
    s_mov_b32 s84, s50
    s_and_b32 s85, s51, 0xffff
    s_waitcnt vmcnt(0)
    s_mov_b32 s60, 0
    buffer_load_dword v96, v5, s[8:11], s60 offen
    s_mov_b32 s60, 110592
    buffer_load_dword v97, v5, s[8:11], s60 offen
    s_mov_b32 s60, 221184
    buffer_load_dword v98, v5, s[8:11], s60 offen
    s_mov_b32 s60, 331776
    buffer_load_dword v99, v5, s[8:11], s60 offen
    s_mov_b32 s60, 442368
    buffer_load_dword v100, v5, s[8:11], s60 offen
    s_mov_b32 s60, 552960
    buffer_load_dword v101, v5, s[8:11], s60 offen
    s_mov_b32 s60, 663552
    buffer_load_dword v102, v5, s[8:11], s60 offen
    s_mov_b32 s60, 774144
    buffer_load_dword v103, v5, s[8:11], s60 offen
    s_mov_b32 s60, 13824
    buffer_load_dword v104, v5, s[8:11], s60 offen
    s_mov_b32 s60, 124416
    buffer_load_dword v105, v5, s[8:11], s60 offen
    s_mov_b32 s60, 235008
    buffer_load_dword v106, v5, s[8:11], s60 offen
    s_mov_b32 s60, 345600
    buffer_load_dword v107, v5, s[8:11], s60 offen
    s_mov_b32 s60, 456192
    buffer_load_dword v108, v5, s[8:11], s60 offen
    s_mov_b32 s60, 566784
    buffer_load_dword v109, v5, s[8:11], s60 offen
    s_mov_b32 s60, 677376
    buffer_load_dword v110, v5, s[8:11], s60 offen
    s_mov_b32 s60, 787968
    buffer_load_dword v111, v5, s[8:11], s60 offen
    s_mov_b32 s60, 27648
    buffer_load_dword v112, v5, s[8:11], s60 offen
    s_mov_b32 s60, 138240
    buffer_load_dword v113, v5, s[8:11], s60 offen
    s_mov_b32 s60, 248832
    buffer_load_dword v114, v5, s[8:11], s60 offen
    s_mov_b32 s60, 359424
    buffer_load_dword v115, v5, s[8:11], s60 offen
    s_mov_b32 s60, 470016
    buffer_load_dword v116, v5, s[8:11], s60 offen
    s_mov_b32 s60, 580608
    buffer_load_dword v117, v5, s[8:11], s60 offen
    s_mov_b32 s60, 691200
    buffer_load_dword v118, v5, s[8:11], s60 offen
    s_mov_b32 s60, 801792
    buffer_load_dword v119, v5, s[8:11], s60 offen
    s_mov_b32 s60, 41472
    buffer_load_dword v120, v5, s[8:11], s60 offen
    s_mov_b32 s60, 152064
    buffer_load_dword v121, v5, s[8:11], s60 offen
    s_mov_b32 s60, 262656
    buffer_load_dword v122, v5, s[8:11], s60 offen
    s_mov_b32 s60, 373248
    buffer_load_dword v123, v5, s[8:11], s60 offen
    s_mov_b32 s60, 483840
    buffer_load_dword v124, v5, s[8:11], s60 offen
    s_mov_b32 s60, 594432
    buffer_load_dword v125, v5, s[8:11], s60 offen
    s_mov_b32 s60, 705024
    buffer_load_dword v126, v5, s[8:11], s60 offen
    s_mov_b32 s60, 815616
    buffer_load_dword v127, v5, s[8:11], s60 offen
    s_mov_b32 s60, 884736
    buffer_load_dword v128, v6, s[8:11], s60 offen
    s_mov_b32 s60, 995328
    buffer_load_dword v129, v6, s[8:11], s60 offen
    s_mov_b32 s60, 888192
    buffer_load_dword v130, v6, s[8:11], s60 offen
    s_mov_b32 s60, 998784
    buffer_load_dword v131, v6, s[8:11], s60 offen
    s_mov_b32 s60, 891648
    buffer_load_dword v132, v6, s[8:11], s60 offen
    s_mov_b32 s60, 1002240
    buffer_load_dword v133, v6, s[8:11], s60 offen
    s_mov_b32 s60, 895104
    buffer_load_dword v134, v6, s[8:11], s60 offen
    s_mov_b32 s60, 1005696
    buffer_load_dword v135, v6, s[8:11], s60 offen
    s_mov_b32 s60, 0
    buffer_load_dword v136, v5, s[12:15], s60 offen
    s_mov_b32 s60, 110592
    buffer_load_dword v137, v5, s[12:15], s60 offen
    s_mov_b32 s60, 221184
    buffer_load_dword v138, v5, s[12:15], s60 offen
    s_mov_b32 s60, 331776
    buffer_load_dword v139, v5, s[12:15], s60 offen
    s_mov_b32 s60, 442368
    buffer_load_dword v140, v5, s[12:15], s60 offen
    s_mov_b32 s60, 552960
    buffer_load_dword v141, v5, s[12:15], s60 offen
    s_mov_b32 s60, 663552
    buffer_load_dword v142, v5, s[12:15], s60 offen
    s_mov_b32 s60, 774144
    buffer_load_dword v143, v5, s[12:15], s60 offen
    s_mov_b32 s60, 13824
    buffer_load_dword v144, v5, s[12:15], s60 offen
    s_mov_b32 s60, 124416
    buffer_load_dword v145, v5, s[12:15], s60 offen
    s_mov_b32 s60, 235008
    buffer_load_dword v146, v5, s[12:15], s60 offen
    s_mov_b32 s60, 345600
    buffer_load_dword v147, v5, s[12:15], s60 offen
    s_mov_b32 s60, 456192
    buffer_load_dword v148, v5, s[12:15], s60 offen
    s_mov_b32 s60, 566784
    buffer_load_dword v149, v5, s[12:15], s60 offen
    s_mov_b32 s60, 677376
    buffer_load_dword v150, v5, s[12:15], s60 offen
    s_mov_b32 s60, 787968
    buffer_load_dword v151, v5, s[12:15], s60 offen
    s_mov_b32 s60, 27648
    buffer_load_dword v152, v5, s[12:15], s60 offen
    s_mov_b32 s60, 138240
    buffer_load_dword v153, v5, s[12:15], s60 offen
    s_mov_b32 s60, 248832
    buffer_load_dword v154, v5, s[12:15], s60 offen
    s_mov_b32 s60, 359424
    buffer_load_dword v155, v5, s[12:15], s60 offen
    s_mov_b32 s60, 470016
    buffer_load_dword v156, v5, s[12:15], s60 offen
    s_mov_b32 s60, 580608
    buffer_load_dword v157, v5, s[12:15], s60 offen
    s_mov_b32 s60, 691200
    buffer_load_dword v158, v5, s[12:15], s60 offen
    s_mov_b32 s60, 801792
    buffer_load_dword v159, v5, s[12:15], s60 offen
    s_mov_b32 s60, 41472
    buffer_load_dword v160, v5, s[12:15], s60 offen
    s_mov_b32 s60, 152064
    buffer_load_dword v161, v5, s[12:15], s60 offen
    s_mov_b32 s60, 262656
    buffer_load_dword v162, v5, s[12:15], s60 offen
    s_mov_b32 s60, 373248
    buffer_load_dword v163, v5, s[12:15], s60 offen
    s_mov_b32 s60, 483840
    buffer_load_dword v164, v5, s[12:15], s60 offen
    s_mov_b32 s60, 594432
    buffer_load_dword v165, v5, s[12:15], s60 offen
    s_mov_b32 s60, 705024
    buffer_load_dword v166, v5, s[12:15], s60 offen
    s_mov_b32 s60, 815616
    buffer_load_dword v167, v5, s[12:15], s60 offen
    s_mov_b32 s60, 884736
    buffer_load_dword v168, v6, s[12:15], s60 offen
    s_mov_b32 s60, 995328
    buffer_load_dword v169, v6, s[12:15], s60 offen
    s_mov_b32 s60, 888192
    buffer_load_dword v170, v6, s[12:15], s60 offen
    s_mov_b32 s60, 998784
    buffer_load_dword v171, v6, s[12:15], s60 offen
    s_mov_b32 s60, 891648
    buffer_load_dword v172, v6, s[12:15], s60 offen
    s_mov_b32 s60, 1002240
    buffer_load_dword v173, v6, s[12:15], s60 offen
    s_mov_b32 s60, 895104
    buffer_load_dword v174, v6, s[12:15], s60 offen
    s_mov_b32 s60, 1005696
    buffer_load_dword v175, v6, s[12:15], s60 offen
    s_waitcnt vmcnt(63)
    v_perm_b32 v16, v97, v96, s58
    v_perm_b32 v20, v97, v96, s59
    v_perm_b32 v17, v99, v98, s58
    v_perm_b32 v21, v99, v98, s59
    v_perm_b32 v18, v101, v100, s58
    v_perm_b32 v22, v101, v100, s59
    v_perm_b32 v19, v103, v102, s58
    v_perm_b32 v23, v103, v102, s59
    s_waitcnt vmcnt(63)
    v_perm_b32 v24, v105, v104, s58
    v_perm_b32 v28, v105, v104, s59
    v_perm_b32 v25, v107, v106, s58
    v_perm_b32 v29, v107, v106, s59
    v_perm_b32 v26, v109, v108, s58
    v_perm_b32 v30, v109, v108, s59
    v_perm_b32 v27, v111, v110, s58
    v_perm_b32 v31, v111, v110, s59
    s_waitcnt vmcnt(56)
    v_perm_b32 v32, v113, v112, s58
    v_perm_b32 v36, v113, v112, s59
    v_perm_b32 v33, v115, v114, s58
    v_perm_b32 v37, v115, v114, s59
    v_perm_b32 v34, v117, v116, s58
    v_perm_b32 v38, v117, v116, s59
    v_perm_b32 v35, v119, v118, s58
    v_perm_b32 v39, v119, v118, s59
    s_waitcnt vmcnt(48)
    v_perm_b32 v40, v121, v120, s58
    v_perm_b32 v44, v121, v120, s59
    v_perm_b32 v41, v123, v122, s58
    v_perm_b32 v45, v123, v122, s59
    v_perm_b32 v42, v125, v124, s58
    v_perm_b32 v46, v125, v124, s59
    v_perm_b32 v43, v127, v126, s58
    v_perm_b32 v47, v127, v126, s59
    s_waitcnt vmcnt(40)
    v_perm_b32 v48, v129, v128, s58
    v_perm_b32 v52, v129, v128, s59
    v_perm_b32 v49, v131, v130, s58
    v_perm_b32 v53, v131, v130, s59
    v_perm_b32 v50, v133, v132, s58
    v_perm_b32 v54, v133, v132, s59
    v_perm_b32 v51, v135, v134, s58
    v_perm_b32 v55, v135, v134, s59
    s_waitcnt vmcnt(32)
    v_perm_b32 v56, v137, v136, s58
    v_perm_b32 v60, v137, v136, s59
    v_perm_b32 v57, v139, v138, s58
    v_perm_b32 v61, v139, v138, s59
    v_perm_b32 v58, v141, v140, s58
    v_perm_b32 v62, v141, v140, s59
    v_perm_b32 v59, v143, v142, s58
    v_perm_b32 v63, v143, v142, s59
    s_waitcnt vmcnt(24)
    v_perm_b32 v64, v145, v144, s58
    v_perm_b32 v68, v145, v144, s59
    v_perm_b32 v65, v147, v146, s58
    v_perm_b32 v69, v147, v146, s59
    v_perm_b32 v66, v149, v148, s58
    v_perm_b32 v70, v149, v148, s59
    v_perm_b32 v67, v151, v150, s58
    v_perm_b32 v71, v151, v150, s59
    s_waitcnt vmcnt(16)
    v_perm_b32 v72, v153, v152, s58
    v_perm_b32 v76, v153, v152, s59
    v_perm_b32 v73, v155, v154, s58
    v_perm_b32 v77, v155, v154, s59
    v_perm_b32 v74, v157, v156, s58
    v_perm_b32 v78, v157, v156, s59
    v_perm_b32 v75, v159, v158, s58
    v_perm_b32 v79, v159, v158, s59
    s_waitcnt vmcnt(8)
    v_perm_b32 v80, v161, v160, s58
    v_perm_b32 v84, v161, v160, s59
    v_perm_b32 v81, v163, v162, s58
    v_perm_b32 v85, v163, v162, s59
    v_perm_b32 v82, v165, v164, s58
    v_perm_b32 v86, v165, v164, s59
    v_perm_b32 v83, v167, v166, s58
    v_perm_b32 v87, v167, v166, s59
    s_waitcnt vmcnt(0)
    v_perm_b32 v88, v169, v168, s58
    v_perm_b32 v92, v169, v168, s59
    v_perm_b32 v89, v171, v170, s58
    v_perm_b32 v93, v171, v170, s59
    v_perm_b32 v90, v173, v172, s58
    v_perm_b32 v94, v173, v172, s59
    v_perm_b32 v91, v175, v174, s58
    v_perm_b32 v95, v175, v174, s59
    v_lshrrev_b32 v200, 6, v0
    v_lshlrev_b32 v200, 9, v200
    v_add_u32 v200, v200, v1
    v_sub_u32 v200, 2047, v200
    v_subrev_u32 v201, 64, v200
    v_subrev_u32 v202, 128, v200
    v_subrev_u32 v203, 192, v200
    v_subrev_u32 v204, 256, v200
    v_subrev_u32 v205, 320, v200
    v_subrev_u32 v206, 384, v200
    v_subrev_u32 v207, 448, v200
    v_lshlrev_b32 v2, 6, v0
    v_lshrrev_b32 v3, 4, v0
    v_lshlrev_b32 v3, 5, v3
    v_add_u32 v3, 24576, v3
    v_and_b32 v4, 15, v1
    v_lshlrev_b32 v4, 5, v4
    v_add_u32 v4, 24576, v4
    v_and_b32 v210, 7, v1
    s_lshl_b32 s60, s21, 8
    v_lshl_add_u32 v7, v210, 4, s60
    s_lshl_b32 s60, s21, 6
    s_add_u32 s60, s60, 1024
    v_lshl_add_u32 v8, v210, 4, s60
    s_mul_i32 s60, s21, 2688
    s_add_u32 s60, s60, 12288
    v_lshrrev_b32 v211, 3, v1
    v_mul_u32_u24 v13, 336, v211
    v_lshl_add_u32 v13, v210, 4, v13
    v_add_u32 v13, s60, v13
    v_mul_u32_u24 v14, 336, v210
    v_lshl_add_u32 v14, v209, 4, v14
    v_add_u32 v14, s60, v14
    s_lshl_b32 s60, s21, 8
    v_lshl_add_u32 v15, v209, 7, s60
    s_lshl_b32 s60, s21, 6
    s_add_u32 s60, s60, 1024
    v_mov_b32 v212, s60
    v_cmp_gt_u32 vcc, 2, v209
    s_nop 1
    v_cndmask_b32 v15, v212, v15, vcc
    s_mul_i32 s60, s21, 2560
    v_mul_u32_u24 v9, 640, v209
    v_lshl_add_u32 v9, v208, 3, v9
    v_add_u32 v9, s60, v9
    v_add_u32 v12, 1280, v9
    v_mul_u32_u24 v10, 40, v211
    s_lshl_b32 s60, s21, 3
    v_add3_u32 v10, v10, v210, s60
    v_lshlrev_b32 v10, 2, v10
    v_lshrrev_b32 v210, 1, v0
    v_lshlrev_b32 v11, 2, v210
    s_lshl_b32 s26, s22, 9
    s_add_u32 s26, s26, 458752
    s_and_b32 s23, s2, 7
    s_lshl_b32 s23, s23, 14
    s_add_u32 s23, s23, 655360
    s_mov_b32 s25, 9437184
    s_mov_b32 s28, 2688
    s_mov_b32 s30, 0xffff00
    s_mov_b32 s31, 0xffff00
    s_mov_b32 s32, 0xff00ff00
    s_mov_b32 s33, 0xff00ff
    s_mov_b32 s27, 0
L_FaLoop_pre:
    s_cmp_lg_u32 s21, 0
    s_cbranch_scc1 Lpolld_67
    s_add_u32 s60, s29, 20480
    s_add_u32 s61, s20, 1
    v_and_b32 v209, 15, v1
    v_lshlrev_b32 v209, 6, v209
    s_mov_b32 s62, 40000
    s_nop 0
Lpoll_66:
    buffer_load_dword v208, v209, s[4:7], s60 offen sc1
    s_waitcnt vmcnt(0)
    v_cmp_ne_u32 vcc, s61, v208
    s_nop 4
    s_cbranch_vccz Lpolld_67
    s_sleep 8
    s_sub_u32 s62, s62, 1
    s_cmp_lg_u32 s62, 0
    s_cbranch_scc1 Lpoll_66
Lpolld_67:
    s_barrier
L_FaLoop:
    s_setprio 0
    s_mov_b32 s62, 40000
    s_mov_b32 exec_lo, 0x0
    s_mov_b32 exec_hi, 0xc0000000
Lrg_69:
    buffer_load_dwordx4 v[192:195], v2, s[4:7], s23 offen sc1
    s_waitcnt vmcnt(0)
    v_max3_u32 v176, v192, v193, v194
    v_max_u32 v176, v176, v195
    v_cmp_eq_u32 vcc, -1, v176
    s_nop 4
    s_cbranch_vccz Lrgd_70
    s_sub_u32 s62, s62, 1
    s_cmp_lg_u32 s62, 0
    s_cbranch_scc1 Lrg_69
Lrgd_70:
    s_mov_b64 exec, -1
    s_mov_b32 s62, 40000
Lrg_71:
    buffer_load_dwordx4 v[192:195], v2, s[4:7], s23 offen sc1
    s_waitcnt vmcnt(0)
    v_max3_u32 v176, v192, v193, v194
    v_max_u32 v176, v176, v195
    v_cmp_eq_u32 vcc, -1, v176
    s_nop 4
    s_cbranch_vccz Lrgd_72
    s_sub_u32 s62, s62, 1
    s_cmp_lg_u32 s62, 0
    s_cbranch_scc1 Lrg_71
Lrgd_72:
    s_mov_b64 exec, -1
    s_setprio 3
Ldry_68:
    s_mov_b32 s63, 0xffff0000
    v_lshl_or_b32 v176, v192, 16, v200
    v_and_or_b32 v177, v192, s63, v201
    v_lshl_or_b32 v178, v193, 16, v202
    v_and_or_b32 v179, v193, s63, v203
    v_lshl_or_b32 v180, v194, 16, v204
    v_and_or_b32 v181, v194, s63, v205
    v_lshl_or_b32 v182, v195, 16, v206
    v_and_or_b32 v183, v195, s63, v207
    v_max_u32 v184, v176, v177
    v_min_u32 v177, v176, v177
    v_max_u32 v185, v178, v179
    v_min_u32 v179, v178, v179
    v_max_u32 v186, v180, v181
    v_min_u32 v181, v180, v181
    v_max_u32 v187, v182, v183
    v_min_u32 v183, v182, v183
    v_max_u32 v188, v184, v185
    v_min_u32 v185, v184, v185
    v_max_u32 v189, v177, v179
    v_min_u32 v179, v177, v179
    v_max_u32 v190, v186, v187
    v_min_u32 v187, v186, v187
    v_max_u32 v191, v181, v183
    v_min_u32 v183, v181, v183
    v_max_u32 v192, v189, v185
    v_min_u32 v185, v189, v185
    v_max_u32 v193, v191, v187
    v_min_u32 v187, v191, v187
    v_max_u32 v194, v188, v190
    v_min_u32 v190, v188, v190
    v_max_u32 v195, v179, v183
    v_min_u32 v183, v179, v183
    v_max_u32 v196, v192, v193
    v_min_u32 v193, v192, v193
    v_max_u32 v197, v185, v187
    v_min_u32 v187, v185, v187
    v_max_u32 v198, v196, v190
    v_min_u32 v190, v196, v190
    v_max_u32 v199, v195, v187
    v_min_u32 v187, v195, v187
    v_max_u32 v176, v197, v190
    v_min_u32 v190, v197, v190
    v_max_u32 v178, v199, v193
    v_min_u32 v193, v199, v193
    v_max_u32 v180, v178, v190
    v_min_u32 v190, v178, v190
    v_max_u32_dpp v182, v183, v194 quad_perm:[1,0,3,2] row_mask:0xf bank_mask:0xf
    v_max_u32_dpp v184, v187, v198 quad_perm:[1,0,3,2] row_mask:0xf bank_mask:0xf
    v_max_u32_dpp v177, v193, v176 quad_perm:[1,0,3,2] row_mask:0xf bank_mask:0xf
    v_max_u32_dpp v186, v190, v180 quad_perm:[1,0,3,2] row_mask:0xf bank_mask:0xf
    v_max_u32_dpp v181, v180, v190 quad_perm:[1,0,3,2] row_mask:0xf bank_mask:0xf
    v_max_u32_dpp v189, v176, v193 quad_perm:[1,0,3,2] row_mask:0xf bank_mask:0xf
    v_max_u32_dpp v191, v198, v187 quad_perm:[1,0,3,2] row_mask:0xf bank_mask:0xf
    v_max_u32_dpp v188, v194, v183 quad_perm:[1,0,3,2] row_mask:0xf bank_mask:0xf
    v_max_u32 v179, v182, v181
    v_min_u32 v181, v182, v181
    v_max_u32 v192, v184, v189
    v_min_u32 v189, v184, v189
    v_max_u32 v185, v177, v191
    v_min_u32 v191, v177, v191
    v_max_u32 v196, v186, v188
    v_min_u32 v188, v186, v188
    v_max_u32 v195, v179, v185
    v_min_u32 v185, v179, v185
    v_max_u32 v197, v192, v196
    v_min_u32 v196, v192, v196
    v_max_u32 v199, v181, v191
    v_min_u32 v191, v181, v191
    v_max_u32 v178, v189, v188
    v_min_u32 v188, v189, v188
    v_max_u32 v194, v191, v188
    v_min_u32 v188, v191, v188
    v_max_u32 v198, v199, v178
    v_min_u32 v178, v199, v178
    v_max_u32 v176, v185, v196
    v_min_u32 v196, v185, v196
    v_max_u32 v180, v195, v197
    v_min_u32 v197, v195, v197
    s_nop 0
    v_max_u32_dpp v190, v188, v180 quad_perm:[2,3,0,1] row_mask:0xf bank_mask:0xf
    v_max_u32_dpp v193, v194, v197 quad_perm:[2,3,0,1] row_mask:0xf bank_mask:0xf
    v_max_u32_dpp v187, v178, v176 quad_perm:[2,3,0,1] row_mask:0xf bank_mask:0xf
    v_max_u32_dpp v183, v198, v196 quad_perm:[2,3,0,1] row_mask:0xf bank_mask:0xf
    v_max_u32_dpp v182, v196, v198 quad_perm:[2,3,0,1] row_mask:0xf bank_mask:0xf
    v_max_u32_dpp v184, v176, v178 quad_perm:[2,3,0,1] row_mask:0xf bank_mask:0xf
    v_max_u32_dpp v177, v197, v194 quad_perm:[2,3,0,1] row_mask:0xf bank_mask:0xf
    v_max_u32_dpp v186, v180, v188 quad_perm:[2,3,0,1] row_mask:0xf bank_mask:0xf
    v_max_u32 v179, v190, v182
    v_min_u32 v182, v190, v182
    v_max_u32 v192, v193, v184
    v_min_u32 v184, v193, v184
    v_max_u32 v181, v187, v177
    v_min_u32 v177, v187, v177
    v_max_u32 v189, v183, v186
    v_min_u32 v186, v183, v186
    v_max_u32 v191, v179, v181
    v_min_u32 v181, v179, v181
    v_max_u32 v199, v192, v189
    v_min_u32 v189, v192, v189
    v_max_u32 v185, v182, v177
    v_min_u32 v177, v182, v177
    v_max_u32 v195, v184, v186
    v_min_u32 v186, v184, v186
    v_max_u32 v180, v177, v186
    v_min_u32 v186, v177, v186
    v_max_u32 v197, v185, v195
    v_min_u32 v195, v185, v195
    v_max_u32 v176, v181, v189
    v_min_u32 v189, v181, v189
    v_max_u32 v196, v191, v199
    v_min_u32 v199, v191, v199
    s_nop 0
    v_max_u32_dpp v198, v186, v196 row_half_mirror row_mask:0xf bank_mask:0xf
    v_max_u32_dpp v178, v180, v199 row_half_mirror row_mask:0xf bank_mask:0xf
    v_max_u32_dpp v194, v195, v176 row_half_mirror row_mask:0xf bank_mask:0xf
    v_max_u32_dpp v188, v197, v189 row_half_mirror row_mask:0xf bank_mask:0xf
    v_max_u32_dpp v190, v189, v197 row_half_mirror row_mask:0xf bank_mask:0xf
    v_max_u32_dpp v193, v176, v195 row_half_mirror row_mask:0xf bank_mask:0xf
    v_max_u32_dpp v187, v199, v180 row_half_mirror row_mask:0xf bank_mask:0xf
    v_max_u32_dpp v183, v196, v186 row_half_mirror row_mask:0xf bank_mask:0xf
    v_max_u32 v179, v198, v190
    v_min_u32 v190, v198, v190
    v_max_u32 v192, v178, v193
    v_min_u32 v193, v178, v193
    v_max_u32 v182, v194, v187
    v_min_u32 v187, v194, v187
    v_max_u32 v184, v188, v183
    v_min_u32 v183, v188, v183
    v_max_u32 v177, v179, v182
    v_min_u32 v182, v179, v182
    v_max_u32 v185, v192, v184
    v_min_u32 v184, v192, v184
    v_max_u32 v181, v190, v187
    v_min_u32 v187, v190, v187
    v_max_u32 v191, v193, v183
    v_min_u32 v183, v193, v183
    v_max_u32 v196, v187, v183
    v_min_u32 v183, v187, v183
    v_max_u32 v199, v181, v191
    v_min_u32 v191, v181, v191
    v_max_u32 v176, v182, v184
    v_min_u32 v184, v182, v184
    v_max_u32 v189, v177, v185
    v_min_u32 v185, v177, v185
    s_nop 0
    v_max_u32_dpp v197, v183, v189 row_mirror row_mask:0xf bank_mask:0xf
    v_max_u32_dpp v195, v196, v185 row_mirror row_mask:0xf bank_mask:0xf
    v_max_u32_dpp v180, v191, v176 row_mirror row_mask:0xf bank_mask:0xf
    v_max_u32_dpp v186, v199, v184 row_mirror row_mask:0xf bank_mask:0xf
    v_max_u32_dpp v198, v184, v199 row_mirror row_mask:0xf bank_mask:0xf
    v_max_u32_dpp v178, v176, v191 row_mirror row_mask:0xf bank_mask:0xf
    v_max_u32_dpp v194, v185, v196 row_mirror row_mask:0xf bank_mask:0xf
    v_max_u32_dpp v188, v189, v183 row_mirror row_mask:0xf bank_mask:0xf
    v_max_u32 v179, v197, v198
    v_min_u32 v198, v197, v198
    v_max_u32 v192, v195, v178
    v_min_u32 v178, v195, v178
    v_max_u32 v190, v180, v194
    v_min_u32 v194, v180, v194
    v_max_u32 v193, v186, v188
    v_min_u32 v188, v186, v188
    v_max_u32 v187, v179, v190
    v_min_u32 v190, v179, v190
    v_max_u32 v181, v192, v193
    v_min_u32 v193, v192, v193
    v_max_u32 v182, v198, v194
    v_min_u32 v194, v198, v194
    v_max_u32 v177, v178, v188
    v_min_u32 v188, v178, v188
    v_max_u32 v208, v187, v181
    v_min_u32 v209, v187, v181
    v_max_u32 v210, v190, v193
    v_min_u32 v211, v190, v193
    v_max_u32 v212, v182, v177
    v_min_u32 v213, v182, v177
    v_max_u32 v214, v194, v188
    v_min_u32 v215, v194, v188
    s_mov_b32 exec_lo, 0x10001
    s_mov_b32 exec_hi, 0x10001
    ds_write_b128 v3, v[208:211]
    ds_write_b128 v3, v[212:215] offset:16
    s_mov_b64 exec, -1
    s_waitcnt lgkmcnt(0)
    s_barrier
    ds_read_b128 v[176:179], v4
    ds_read_b128 v[180:183], v4 offset:16
    s_waitcnt lgkmcnt(0)
    v_max_u32_dpp v184, v183, v176 quad_perm:[1,0,3,2] row_mask:0xf bank_mask:0xf
    v_max_u32_dpp v185, v182, v177 quad_perm:[1,0,3,2] row_mask:0xf bank_mask:0xf
    v_max_u32_dpp v186, v181, v178 quad_perm:[1,0,3,2] row_mask:0xf bank_mask:0xf
    v_max_u32_dpp v187, v180, v179 quad_perm:[1,0,3,2] row_mask:0xf bank_mask:0xf
    v_max_u32_dpp v188, v179, v180 quad_perm:[1,0,3,2] row_mask:0xf bank_mask:0xf
    v_max_u32_dpp v189, v178, v181 quad_perm:[1,0,3,2] row_mask:0xf bank_mask:0xf
    v_max_u32_dpp v190, v177, v182 quad_perm:[1,0,3,2] row_mask:0xf bank_mask:0xf
    v_max_u32_dpp v191, v176, v183 quad_perm:[1,0,3,2] row_mask:0xf bank_mask:0xf
    v_max_u32 v192, v184, v188
    v_min_u32 v188, v184, v188
    v_max_u32 v193, v185, v189
    v_min_u32 v189, v185, v189
    v_max_u32 v194, v186, v190
    v_min_u32 v190, v186, v190
    v_max_u32 v195, v187, v191
    v_min_u32 v191, v187, v191
    v_max_u32 v196, v192, v194
    v_min_u32 v194, v192, v194
    v_max_u32 v197, v193, v195
    v_min_u32 v195, v193, v195
    v_max_u32 v198, v188, v190
    v_min_u32 v190, v188, v190
    v_max_u32 v199, v189, v191
    v_min_u32 v191, v189, v191
    v_max_u32 v176, v190, v191
    v_min_u32 v191, v190, v191
    v_max_u32 v177, v198, v199
    v_min_u32 v199, v198, v199
    v_max_u32 v178, v194, v195
    v_min_u32 v195, v194, v195
    v_max_u32 v179, v196, v197
    v_min_u32 v197, v196, v197
    s_nop 0
    v_max_u32_dpp v180, v191, v179 quad_perm:[2,3,0,1] row_mask:0xf bank_mask:0xf
    v_max_u32_dpp v181, v176, v197 quad_perm:[2,3,0,1] row_mask:0xf bank_mask:0xf
    v_max_u32_dpp v182, v199, v178 quad_perm:[2,3,0,1] row_mask:0xf bank_mask:0xf
    v_max_u32_dpp v183, v177, v195 quad_perm:[2,3,0,1] row_mask:0xf bank_mask:0xf
    v_max_u32_dpp v184, v195, v177 quad_perm:[2,3,0,1] row_mask:0xf bank_mask:0xf
    v_max_u32_dpp v185, v178, v199 quad_perm:[2,3,0,1] row_mask:0xf bank_mask:0xf
    v_max_u32_dpp v186, v197, v176 quad_perm:[2,3,0,1] row_mask:0xf bank_mask:0xf
    v_max_u32_dpp v187, v179, v191 quad_perm:[2,3,0,1] row_mask:0xf bank_mask:0xf
    v_max_u32 v192, v180, v184
    v_min_u32 v184, v180, v184
    v_max_u32 v193, v181, v185
    v_min_u32 v185, v181, v185
    v_max_u32 v188, v182, v186
    v_min_u32 v186, v182, v186
    v_max_u32 v189, v183, v187
    v_min_u32 v187, v183, v187
    v_max_u32 v190, v192, v188
    v_min_u32 v188, v192, v188
    v_max_u32 v198, v193, v189
    v_min_u32 v189, v193, v189
    v_max_u32 v194, v184, v186
    v_min_u32 v186, v184, v186
    v_max_u32 v196, v185, v187
    v_min_u32 v187, v185, v187
    v_max_u32 v179, v186, v187
    v_min_u32 v187, v186, v187
    v_max_u32 v197, v194, v196
    v_min_u32 v196, v194, v196
    v_max_u32 v178, v188, v189
    v_min_u32 v189, v188, v189
    v_max_u32 v195, v190, v198
    v_min_u32 v198, v190, v198
    s_nop 0
    v_max_u32_dpp v177, v187, v195 row_half_mirror row_mask:0xf bank_mask:0xf
    v_max_u32_dpp v199, v179, v198 row_half_mirror row_mask:0xf bank_mask:0xf
    v_max_u32_dpp v176, v196, v178 row_half_mirror row_mask:0xf bank_mask:0xf
    v_max_u32_dpp v191, v197, v189 row_half_mirror row_mask:0xf bank_mask:0xf
    v_max_u32_dpp v180, v189, v197 row_half_mirror row_mask:0xf bank_mask:0xf
    v_max_u32_dpp v181, v178, v196 row_half_mirror row_mask:0xf bank_mask:0xf
    v_max_u32_dpp v182, v198, v179 row_half_mirror row_mask:0xf bank_mask:0xf
    v_max_u32_dpp v183, v195, v187 row_half_mirror row_mask:0xf bank_mask:0xf
    v_max_u32 v192, v177, v180
    v_min_u32 v180, v177, v180
    v_max_u32 v193, v199, v181
    v_min_u32 v181, v199, v181
    v_max_u32 v184, v176, v182
    v_min_u32 v182, v176, v182
    v_max_u32 v185, v191, v183
    v_min_u32 v183, v191, v183
    v_max_u32 v186, v192, v184
    v_min_u32 v184, v192, v184
    v_max_u32 v194, v193, v185
    v_min_u32 v185, v193, v185
    v_max_u32 v188, v180, v182
    v_min_u32 v182, v180, v182
    v_max_u32 v190, v181, v183
    v_min_u32 v183, v181, v183
    v_max_u32 v195, v182, v183
    v_min_u32 v183, v182, v183
    v_max_u32 v198, v188, v190
    v_min_u32 v190, v188, v190
    v_max_u32 v178, v184, v185
    v_min_u32 v185, v184, v185
    v_max_u32 v189, v186, v194
    v_min_u32 v194, v186, v194
    s_nop 0
    v_max_u32_dpp v197, v183, v189 row_mirror row_mask:0xf bank_mask:0xf
    v_max_u32_dpp v196, v195, v194 row_mirror row_mask:0xf bank_mask:0xf
    v_max_u32_dpp v179, v190, v178 row_mirror row_mask:0xf bank_mask:0xf
    v_max_u32_dpp v187, v198, v185 row_mirror row_mask:0xf bank_mask:0xf
    v_max_u32_dpp v177, v185, v198 row_mirror row_mask:0xf bank_mask:0xf
    v_max_u32_dpp v199, v178, v190 row_mirror row_mask:0xf bank_mask:0xf
    v_max_u32_dpp v176, v194, v195 row_mirror row_mask:0xf bank_mask:0xf
    v_max_u32_dpp v191, v189, v183 row_mirror row_mask:0xf bank_mask:0xf
    v_cndmask_b32 v208, v197, v179, s[30:31]
    v_cndmask_b32 v209, v177, v176, s[30:31]
    v_cndmask_b32 v208, v208, v209, s[32:33]
    v_and_b32 v208, 0x7ff, v208
    v_sub_u32 v208, 2047, v208
    v_mad_u32_u24 v209, v208, s28, v7
    v_mad_u32_u24 v210, v208, s28, v8
    v_min3_u32 v211, v197, v196, v179
    v_min3_u32 v212, v187, v177, v199
    v_min3_u32 v211, v211, v176, v191
    v_min_u32 v211, v211, v212
    v_and_b32 v211, 0xffff0000, v211
    v_cmp_gt_u32 vcc, s36, v211
    s_nop 4
    s_cbranch_vccz Lgad_74
    v_mul_u32_u24 v211, s28, v208
    s_add_u32 s61, s20, 6
    s_add_u32 s61, s61, s27
    s_mov_b32 s62, 40000
Lga_73:
    buffer_load_dword v212, v211, s[4:7], s25 offen offset:2568 sc1
    s_waitcnt vmcnt(0)
    v_cmp_ne_u32 vcc, s61, v212
    s_nop 4
    s_cbranch_vccz Lgad_74
    s_sleep 2
    s_sub_u32 s62, s62, 1
    s_cmp_lg_u32 s62, 0
    s_cbranch_scc1 Lga_73
Lgad_74:
    buffer_load_dwordx4 v[176:179], v209, s[4:7], s25 offen sc1
    buffer_load_dwordx4 v[180:183], v209, s[4:7], s25 offen offset:128 sc1
    s_mov_b32 exec_lo, 0xf0f0f0f
    s_mov_b32 exec_hi, 0xf0f0f0f
    buffer_load_dwordx4 v[184:187], v210, s[4:7], s25 offen sc1
    s_mov_b64 exec, -1
    s_waitcnt vmcnt(2)
    ds_write_b128 v13, v[176:179]
    s_waitcnt vmcnt(1)
    ds_write_b128 v13, v[180:183] offset:128
    s_waitcnt vmcnt(0)
    s_mov_b32 exec_lo, 0xf0f0f0f
    s_mov_b32 exec_hi, 0xf0f0f0f
    ds_write_b128 v13, v[184:187] offset:256
    s_mov_b64 exec, -1
    ds_read_b128 v[136:139], v14 offset:0
    ds_read_b128 v[140:143], v14 offset:64
    ds_read_b128 v[144:147], v14 offset:128
    ds_read_b128 v[148:151], v14 offset:192
    ds_read_b128 v[152:155], v14 offset:256
    s_waitcnt lgkmcnt(4)
    v_mfma_f32_16x16x32_bf16 v[156:159], v[136:139], v[16:19], 0
    v_mfma_f32_16x16x32_bf16 v[160:163], v[136:139], v[20:23], 0
    v_mfma_f32_16x16x32_bf16 v[164:167], v[136:139], v[56:59], 0
    v_mfma_f32_16x16x32_bf16 v[168:171], v[136:139], v[60:63], 0
    s_waitcnt lgkmcnt(3)
    v_mfma_f32_16x16x32_bf16 v[156:159], v[140:143], v[24:27], v[156:159]
    v_mfma_f32_16x16x32_bf16 v[160:163], v[140:143], v[28:31], v[160:163]
    v_mfma_f32_16x16x32_bf16 v[164:167], v[140:143], v[64:67], v[164:167]
    v_mfma_f32_16x16x32_bf16 v[168:171], v[140:143], v[68:71], v[168:171]
    s_waitcnt lgkmcnt(2)
    v_mfma_f32_16x16x32_bf16 v[156:159], v[144:147], v[32:35], v[156:159]
    v_mfma_f32_16x16x32_bf16 v[160:163], v[144:147], v[36:39], v[160:163]
    v_mfma_f32_16x16x32_bf16 v[164:167], v[144:147], v[72:75], v[164:167]
    v_mfma_f32_16x16x32_bf16 v[168:171], v[144:147], v[76:79], v[168:171]
    s_waitcnt lgkmcnt(1)
    v_mfma_f32_16x16x32_bf16 v[156:159], v[148:151], v[40:43], v[156:159]
    v_mfma_f32_16x16x32_bf16 v[160:163], v[148:151], v[44:47], v[160:163]
    v_mfma_f32_16x16x32_bf16 v[164:167], v[148:151], v[80:83], v[164:167]
    v_mfma_f32_16x16x32_bf16 v[168:171], v[148:151], v[84:87], v[168:171]
    s_waitcnt lgkmcnt(0)
    v_mfma_f32_16x16x32_bf16 v[156:159], v[152:155], v[48:51], v[156:159]
    v_mfma_f32_16x16x32_bf16 v[160:163], v[152:155], v[52:55], v[160:163]
    v_mfma_f32_16x16x32_bf16 v[164:167], v[152:155], v[88:91], v[164:167]
    v_mfma_f32_16x16x32_bf16 v[168:171], v[152:155], v[92:95], v[168:171]
    s_mov_b32 exec_lo, 0xffffffff
    s_mov_b32 exec_hi, 0x0
    s_nop 3
    ds_write2_b32 v9, v156, v160 offset0:0 offset1:1
    ds_write2_b32 v9, v157, v161 offset0:40 offset1:41
    ds_write2_b32 v9, v158, v162 offset0:80 offset1:81
    ds_write2_b32 v9, v159, v163 offset0:120 offset1:121
    ds_write2_b32 v12, v164, v168 offset0:0 offset1:1
    ds_write2_b32 v12, v165, v169 offset0:40 offset1:41
    ds_write2_b32 v12, v166, v170 offset0:80 offset1:81
    ds_write2_b32 v12, v167, v171 offset0:120 offset1:121
    s_mov_b64 exec, -1
    s_waitcnt lgkmcnt(0)
    s_barrier
    ds_read2st64_b32 v[208:209], v10 offset0:0 offset1:5
    ds_read2st64_b32 v[210:211], v10 offset0:10 offset1:15
    ds_read2st64_b32 v[212:213], v10 offset0:20 offset1:25
    ds_read2st64_b32 v[214:215], v10 offset0:30 offset1:35
    s_waitcnt lgkmcnt(2)
    v_pk_add_f32 v[208:209], v[208:209], v[210:211]
    s_waitcnt lgkmcnt(0)
    v_pk_add_f32 v[212:213], v[212:213], v[214:215]
    v_pk_add_f32 v[208:209], v[208:209], v[212:213]
    v_cvt_pk_bf16_f32 v210, v208, v209
    v_lshlrev_b32 v208, 16, v210
    v_and_b32 v209, 0xffff0000, v210
    v_mul_f32 v210, 0xbfb8aa3b, v208
    v_exp_f32 v210, v210
    s_nop 0
    v_add_f32 v210, 1.0, v210
    v_rcp_f32 v210, v210
    s_nop 0
    v_mul_f32 v208, v208, v210
    v_cvt_pk_bf16_f32 v208, v208, v208
    v_and_b32 v208, 0xffff0000, v208
    v_mul_f32 v208, v208, v209
    s_nop 1
    v_mov_b32_dpp v209, v208 quad_perm:[1,0,3,2] row_mask:0xf bank_mask:0xf
    v_cvt_pk_bf16_f32 v208, v208, v209
    v_min_u32 v208, -2, v208
    s_mov_b32 exec_lo, 0x55555555
    s_mov_b32 exec_hi, 0x55555555
    buffer_store_dword v208, v11, s[4:7], s26 offen sc1
    s_mov_b64 exec, -1
    s_add_u32 s26, s26, 57344
    s_add_u32 s23, s23, 131072
    s_add_u32 s25, s25, 5505024
    s_add_u32 s27, s27, 1
    s_cmp_lt_u32 s27, 2
    s_cbranch_scc1 L_FaLoop
    s_endpgm
L_roleFb:
    v_mov_b32 v232, 0
    buffer_load_dword v232, v232, s[4:7], 0 offen
    s_and_b32 s61, s2, 7
    s_sub_u32 s60, s2, 256
    s_lshr_b32 s60, s60, 3
    s_mov_b32 s84, s46
    s_and_b32 s85, s47, 0xffff
    s_mov_b32 s86, 2211840
    s_mov_b32 s87, 0x00020000
    v_lshrrev_b32 v240, 2, v0
    v_and_b32 v241, 3, v0
    v_min_u32 v240, 22, v240
    s_mul_i32 s64, s60, 23
    v_add_u32 v240, s64, v240
    s_mul_i32 s63, s61, 7
    s_sub_u32 s63, s63, 1
    s_max_i32 s63, s63, 0
    s_lshl_b32 s63, s63, 6
    s_and_b32 s63, s63, -128
    v_lshl_add_u32 v241, v241, 7, s63
    s_movk_i32 s64, 3456
    v_mad_u32_u24 v241, v240, s64, v241
    buffer_load_dword v243, v241, s[84:87], 0 offen
    v_lshrrev_b32 v240, 1, v0
    v_and_b32 v241, 1, v0
    v_min_u32 v240, 59, v240
    s_mul_i32 s64, s60, 60
    v_add_u32 v240, s64, v240
    s_mul_i32 s63, s61, 3
    s_lshl_b32 s62, s61, 1
    s_add_u32 s62, s62, 3
    s_min_u32 s63, s63, s62
    s_lshl_b32 s63, s63, 6
    s_and_b32 s63, s63, -128
    v_lshl_add_u32 v241, v241, 7, s63
    s_movk_i32 s64, 1280
    v_mad_u32_u24 v241, v240, s64, v241
    s_mov_b32 s84, s50
    s_and_b32 s85, s51, 0xffff
    buffer_load_dword v243, v241, s[84:87], 0 offen
    s_mov_b32 s8, s50
    s_and_b32 s9, s51, 0xffff
    s_mov_b32 s10, 2211840
    s_mov_b32 s11, 0x00020000
    s_mov_b32 s12, s52
    s_and_b32 s13, s53, 0xffff
    s_mov_b32 s14, 2621440
    s_mov_b32 s15, 0x00020000
    s_sub_u32 s60, s2, 464
    s_and_b32 s61, s60, 7
    s_lshr_b32 s60, s60, 3
    s_mul_i32 s22, s61, 3
    s_lshl_b32 s62, s61, 1
    s_add_u32 s62, s62, 3
    s_min_u32 s22, s22, s62
    s_add_u32 s22, s22, s60
    s_cmp_eq_u32 s61, 7
    s_cselect_b32 s60, 0, 1
    s_sub_u32 s22, s22, s60
    s_mov_b32 s58, 0x05040100
    s_mov_b32 s59, 0x07060302
    v_and_b32 v224, 15, v1
    v_lshrrev_b32 v225, 4, v1
    s_lshl_b32 s60, s21, 5
    v_lshl_add_u32 v5, v225, 3, s60
    v_mul_u32_u24 v5, 1280, v5
    s_lshl_b32 s61, s22, 6
    v_lshl_add_u32 v226, v224, 2, s61
    v_add_u32 v5, v5, v226
    v_mov_b32 v12, v224
    v_mov_b32 v13, v225
    s_waitcnt vmcnt(0)
    v_readfirstlane_b32 s20, v232
    s_nop 0
    s_add_u32 s20, s20, 0x9e3779b9
    s_and_b32 s29, s2, 15
    s_lshl_b32 s29, s29, 10
    s_cmp_lg_u32 s21, 0
    s_cbranch_scc1 Lpolld_76
    s_add_u32 s60, s29, 4096
    s_add_u32 s61, s20, 0
    v_and_b32 v229, 15, v1
    v_lshlrev_b32 v229, 6, v229
    s_mov_b32 s62, 40000
    s_nop 0
Lpoll_75:
    buffer_load_dword v228, v229, s[4:7], s60 offen sc1
    s_waitcnt vmcnt(0)
    v_cmp_ne_u32 vcc, s61, v228
    s_nop 4
    s_cbranch_vccz Lpolld_76
    s_sleep 2
    s_sub_u32 s62, s62, 1
    s_cmp_lg_u32 s62, 0
    s_cbranch_scc1 Lpoll_75
Lpolld_76:
    s_barrier
    s_and_b32 s61, s2, 7
    s_sub_u32 s60, s2, 416
    s_lshr_b32 s60, s60, 3
    s_cmp_eq_u32 s61, 0
    s_cselect_b32 s62, 1, 0
    s_sub_u32 s60, s60, s62
    s_min_u32 s60, s60, 8
    s_mul_i32 s63, s61, 7
    s_sub_u32 s63, s63, 1
    s_max_i32 s63, s63, 0
    s_lshl_b32 s63, s63, 6
    s_and_b32 s63, s63, -128
    v_and_b32 v241, 3, v0
    v_lshl_add_u32 v241, v241, 7, s63
    s_mul_i32 s64, s60, 72
    s_movk_i32 s65, 3456
    s_mov_b32 s84, s46
    s_and_b32 s85, s47, 0xffff
    s_mov_b32 s86, 2211840
    s_mov_b32 s87, 0x00020000
    s_mov_b32 s88, s48
    s_and_b32 s89, s49, 0xffff
    s_mov_b32 s90, 2211840
    s_mov_b32 s91, 0x00020000
    v_lshrrev_b32 v240, 2, v0
    v_add_u32 v240, 0, v240
    v_min_u32 v240, 71, v240
    v_add_u32 v240, s64, v240
    v_mad_u32_u24 v240, v240, s65, v241
    buffer_load_dword v243, v240, s[88:91], 0 offen
    v_lshrrev_b32 v240, 2, v0
    v_add_u32 v240, 64, v240
    v_min_u32 v240, 71, v240
    v_add_u32 v240, s64, v240
    v_mad_u32_u24 v240, v240, s65, v241
    s_mov_b32 exec_lo, 0xffffffff
    s_mov_b32 exec_hi, 0x0
    buffer_load_dword v243, v240, s[88:91], 0 offen
    s_mov_b64 exec, -1
    s_mul_i32 s63, s61, 3
    s_lshl_b32 s62, s61, 1
    s_add_u32 s62, s62, 3
    s_min_u32 s63, s63, s62
    s_lshl_b32 s63, s63, 6
    s_and_b32 s63, s63, -128
    v_and_b32 v241, 1, v0
    v_lshl_add_u32 v241, v241, 7, s63
    s_mul_i32 s64, s60, 192
    s_movk_i32 s65, 1280
    s_mov_b32 s84, s50
    s_and_b32 s85, s51, 0xffff
    s_waitcnt vmcnt(0)
    s_mov_b32 s60, 0
    buffer_load_dword v128, v5, s[8:11], s60 offen
    s_mov_b32 s60, 1280
    buffer_load_dword v129, v5, s[8:11], s60 offen
    s_mov_b32 s60, 2560
    buffer_load_dword v130, v5, s[8:11], s60 offen
    s_mov_b32 s60, 3840
    buffer_load_dword v131, v5, s[8:11], s60 offen
    s_mov_b32 s60, 5120
    buffer_load_dword v132, v5, s[8:11], s60 offen
    s_mov_b32 s60, 6400
    buffer_load_dword v133, v5, s[8:11], s60 offen
    s_mov_b32 s60, 7680
    buffer_load_dword v134, v5, s[8:11], s60 offen
    s_mov_b32 s60, 8960
    buffer_load_dword v135, v5, s[8:11], s60 offen
    s_mov_b32 s60, 163840
    buffer_load_dword v136, v5, s[8:11], s60 offen
    s_mov_b32 s60, 165120
    buffer_load_dword v137, v5, s[8:11], s60 offen
    s_mov_b32 s60, 166400
    buffer_load_dword v138, v5, s[8:11], s60 offen
    s_mov_b32 s60, 167680
    buffer_load_dword v139, v5, s[8:11], s60 offen
    s_mov_b32 s60, 168960
    buffer_load_dword v140, v5, s[8:11], s60 offen
    s_mov_b32 s60, 170240
    buffer_load_dword v141, v5, s[8:11], s60 offen
    s_mov_b32 s60, 171520
    buffer_load_dword v142, v5, s[8:11], s60 offen
    s_mov_b32 s60, 172800
    buffer_load_dword v143, v5, s[8:11], s60 offen
    s_mov_b32 s60, 327680
    buffer_load_dword v144, v5, s[8:11], s60 offen
    s_mov_b32 s60, 328960
    buffer_load_dword v145, v5, s[8:11], s60 offen
    s_mov_b32 s60, 330240
    buffer_load_dword v146, v5, s[8:11], s60 offen
    s_mov_b32 s60, 331520
    buffer_load_dword v147, v5, s[8:11], s60 offen
    s_mov_b32 s60, 332800
    buffer_load_dword v148, v5, s[8:11], s60 offen
    s_mov_b32 s60, 334080
    buffer_load_dword v149, v5, s[8:11], s60 offen
    s_mov_b32 s60, 335360
    buffer_load_dword v150, v5, s[8:11], s60 offen
    s_mov_b32 s60, 336640
    buffer_load_dword v151, v5, s[8:11], s60 offen
    s_mov_b32 s60, 491520
    buffer_load_dword v152, v5, s[8:11], s60 offen
    s_mov_b32 s60, 492800
    buffer_load_dword v153, v5, s[8:11], s60 offen
    s_mov_b32 s60, 494080
    buffer_load_dword v154, v5, s[8:11], s60 offen
    s_mov_b32 s60, 495360
    buffer_load_dword v155, v5, s[8:11], s60 offen
    s_mov_b32 s60, 496640
    buffer_load_dword v156, v5, s[8:11], s60 offen
    s_mov_b32 s60, 497920
    buffer_load_dword v157, v5, s[8:11], s60 offen
    s_mov_b32 s60, 499200
    buffer_load_dword v158, v5, s[8:11], s60 offen
    s_mov_b32 s60, 500480
    buffer_load_dword v159, v5, s[8:11], s60 offen
    s_mov_b32 s60, 655360
    buffer_load_dword v160, v5, s[8:11], s60 offen
    s_mov_b32 s60, 656640
    buffer_load_dword v161, v5, s[8:11], s60 offen
    s_mov_b32 s60, 657920
    buffer_load_dword v162, v5, s[8:11], s60 offen
    s_mov_b32 s60, 659200
    buffer_load_dword v163, v5, s[8:11], s60 offen
    s_mov_b32 s60, 660480
    buffer_load_dword v164, v5, s[8:11], s60 offen
    s_mov_b32 s60, 661760
    buffer_load_dword v165, v5, s[8:11], s60 offen
    s_mov_b32 s60, 663040
    buffer_load_dword v166, v5, s[8:11], s60 offen
    s_mov_b32 s60, 664320
    buffer_load_dword v167, v5, s[8:11], s60 offen
    s_mov_b32 s60, 819200
    buffer_load_dword v168, v5, s[8:11], s60 offen
    s_mov_b32 s60, 820480
    buffer_load_dword v169, v5, s[8:11], s60 offen
    s_mov_b32 s60, 821760
    buffer_load_dword v170, v5, s[8:11], s60 offen
    s_mov_b32 s60, 823040
    buffer_load_dword v171, v5, s[8:11], s60 offen
    s_mov_b32 s60, 824320
    buffer_load_dword v172, v5, s[8:11], s60 offen
    s_mov_b32 s60, 825600
    buffer_load_dword v173, v5, s[8:11], s60 offen
    s_mov_b32 s60, 826880
    buffer_load_dword v174, v5, s[8:11], s60 offen
    s_mov_b32 s60, 828160
    buffer_load_dword v175, v5, s[8:11], s60 offen
    s_mov_b32 s60, 983040
    buffer_load_dword v176, v5, s[8:11], s60 offen
    s_mov_b32 s60, 984320
    buffer_load_dword v177, v5, s[8:11], s60 offen
    s_mov_b32 s60, 985600
    buffer_load_dword v178, v5, s[8:11], s60 offen
    s_mov_b32 s60, 986880
    buffer_load_dword v179, v5, s[8:11], s60 offen
    s_mov_b32 s60, 988160
    buffer_load_dword v180, v5, s[8:11], s60 offen
    s_mov_b32 s60, 989440
    buffer_load_dword v181, v5, s[8:11], s60 offen
    s_mov_b32 s60, 990720
    buffer_load_dword v182, v5, s[8:11], s60 offen
    s_mov_b32 s60, 992000
    buffer_load_dword v183, v5, s[8:11], s60 offen
    s_mov_b32 s60, 1146880
    buffer_load_dword v184, v5, s[8:11], s60 offen
    s_mov_b32 s60, 1148160
    buffer_load_dword v185, v5, s[8:11], s60 offen
    s_mov_b32 s60, 1149440
    buffer_load_dword v186, v5, s[8:11], s60 offen
    s_mov_b32 s60, 1150720
    buffer_load_dword v187, v5, s[8:11], s60 offen
    s_mov_b32 s60, 1152000
    buffer_load_dword v188, v5, s[8:11], s60 offen
    s_mov_b32 s60, 1153280
    buffer_load_dword v189, v5, s[8:11], s60 offen
    s_mov_b32 s60, 1154560
    buffer_load_dword v190, v5, s[8:11], s60 offen
    s_mov_b32 s60, 1155840
    buffer_load_dword v191, v5, s[8:11], s60 offen
    s_mov_b32 s60, 1310720
    buffer_load_dword v192, v5, s[8:11], s60 offen
    s_mov_b32 s60, 1312000
    buffer_load_dword v193, v5, s[8:11], s60 offen
    s_mov_b32 s60, 1313280
    buffer_load_dword v194, v5, s[8:11], s60 offen
    s_mov_b32 s60, 1314560
    buffer_load_dword v195, v5, s[8:11], s60 offen
    s_mov_b32 s60, 1315840
    buffer_load_dword v196, v5, s[8:11], s60 offen
    s_mov_b32 s60, 1317120
    buffer_load_dword v197, v5, s[8:11], s60 offen
    s_mov_b32 s60, 1318400
    buffer_load_dword v198, v5, s[8:11], s60 offen
    s_mov_b32 s60, 1319680
    buffer_load_dword v199, v5, s[8:11], s60 offen
    s_mov_b32 s60, 1474560
    buffer_load_dword v200, v5, s[8:11], s60 offen
    s_mov_b32 s60, 1475840
    buffer_load_dword v201, v5, s[8:11], s60 offen
    s_mov_b32 s60, 1477120
    buffer_load_dword v202, v5, s[8:11], s60 offen
    s_mov_b32 s60, 1478400
    buffer_load_dword v203, v5, s[8:11], s60 offen
    s_mov_b32 s60, 1479680
    buffer_load_dword v204, v5, s[8:11], s60 offen
    s_mov_b32 s60, 1480960
    buffer_load_dword v205, v5, s[8:11], s60 offen
    s_mov_b32 s60, 1482240
    buffer_load_dword v206, v5, s[8:11], s60 offen
    s_mov_b32 s60, 1483520
    buffer_load_dword v207, v5, s[8:11], s60 offen
    s_mov_b32 s60, 1638400
    buffer_load_dword v208, v5, s[8:11], s60 offen
    s_mov_b32 s60, 1639680
    buffer_load_dword v209, v5, s[8:11], s60 offen
    s_mov_b32 s60, 1640960
    buffer_load_dword v210, v5, s[8:11], s60 offen
    s_mov_b32 s60, 1642240
    buffer_load_dword v211, v5, s[8:11], s60 offen
    s_mov_b32 s60, 1643520
    buffer_load_dword v212, v5, s[8:11], s60 offen
    s_mov_b32 s60, 1644800
    buffer_load_dword v213, v5, s[8:11], s60 offen
    s_mov_b32 s60, 1646080
    buffer_load_dword v214, v5, s[8:11], s60 offen
    s_mov_b32 s60, 1647360
    buffer_load_dword v215, v5, s[8:11], s60 offen
    s_mov_b32 s60, 1802240
    buffer_load_dword v216, v5, s[8:11], s60 offen
    s_mov_b32 s60, 1803520
    buffer_load_dword v217, v5, s[8:11], s60 offen
    s_mov_b32 s60, 1804800
    buffer_load_dword v218, v5, s[8:11], s60 offen
    s_mov_b32 s60, 1806080
    buffer_load_dword v219, v5, s[8:11], s60 offen
    s_mov_b32 s60, 1807360
    buffer_load_dword v220, v5, s[8:11], s60 offen
    s_mov_b32 s60, 1808640
    buffer_load_dword v221, v5, s[8:11], s60 offen
    s_mov_b32 s60, 1809920
    buffer_load_dword v222, v5, s[8:11], s60 offen
    s_mov_b32 s60, 1811200
    buffer_load_dword v223, v5, s[8:11], s60 offen
    s_mov_b32 s60, 1966080
    buffer_load_dword v224, v5, s[8:11], s60 offen
    s_mov_b32 s60, 1967360
    buffer_load_dword v225, v5, s[8:11], s60 offen
    s_mov_b32 s60, 1968640
    buffer_load_dword v226, v5, s[8:11], s60 offen
    s_mov_b32 s60, 1969920
    buffer_load_dword v227, v5, s[8:11], s60 offen
    s_mov_b32 s60, 1971200
    buffer_load_dword v228, v5, s[8:11], s60 offen
    s_mov_b32 s60, 1972480
    buffer_load_dword v229, v5, s[8:11], s60 offen
    s_mov_b32 s60, 1973760
    buffer_load_dword v230, v5, s[8:11], s60 offen
    s_mov_b32 s60, 1975040
    buffer_load_dword v231, v5, s[8:11], s60 offen
    v_add_u32 v232, 2129920, v5
    buffer_load_dword v232, v232, s[8:11], 0 offen
    v_add_u32 v233, 2131200, v5
    buffer_load_dword v233, v233, s[8:11], 0 offen
    v_add_u32 v234, 2132480, v5
    buffer_load_dword v234, v234, s[8:11], 0 offen
    v_add_u32 v235, 2133760, v5
    buffer_load_dword v235, v235, s[8:11], 0 offen
    v_add_u32 v236, 2135040, v5
    buffer_load_dword v236, v236, s[8:11], 0 offen
    v_add_u32 v237, 2136320, v5
    buffer_load_dword v237, v237, s[8:11], 0 offen
    v_add_u32 v238, 2137600, v5
    buffer_load_dword v238, v238, s[8:11], 0 offen
    v_add_u32 v239, 2138880, v5
    buffer_load_dword v239, v239, s[8:11], 0 offen
    s_waitcnt vmcnt(63)
    v_perm_b32 v16, v129, v128, s58
    v_perm_b32 v20, v129, v128, s59
    v_perm_b32 v17, v131, v130, s58
    v_perm_b32 v21, v131, v130, s59
    v_perm_b32 v18, v133, v132, s58
    v_perm_b32 v22, v133, v132, s59
    v_perm_b32 v19, v135, v134, s58
    v_perm_b32 v23, v135, v134, s59
    s_waitcnt vmcnt(63)
    v_perm_b32 v24, v137, v136, s58
    v_perm_b32 v28, v137, v136, s59
    v_perm_b32 v25, v139, v138, s58
    v_perm_b32 v29, v139, v138, s59
    v_perm_b32 v26, v141, v140, s58
    v_perm_b32 v30, v141, v140, s59
    v_perm_b32 v27, v143, v142, s58
    v_perm_b32 v31, v143, v142, s59
    s_waitcnt vmcnt(63)
    v_perm_b32 v32, v145, v144, s58
    v_perm_b32 v36, v145, v144, s59
    v_perm_b32 v33, v147, v146, s58
    v_perm_b32 v37, v147, v146, s59
    v_perm_b32 v34, v149, v148, s58
    v_perm_b32 v38, v149, v148, s59
    v_perm_b32 v35, v151, v150, s58
    v_perm_b32 v39, v151, v150, s59
    s_waitcnt vmcnt(63)
    v_perm_b32 v40, v153, v152, s58
    v_perm_b32 v44, v153, v152, s59
    v_perm_b32 v41, v155, v154, s58
    v_perm_b32 v45, v155, v154, s59
    v_perm_b32 v42, v157, v156, s58
    v_perm_b32 v46, v157, v156, s59
    v_perm_b32 v43, v159, v158, s58
    v_perm_b32 v47, v159, v158, s59
    s_waitcnt vmcnt(63)
    v_perm_b32 v48, v161, v160, s58
    v_perm_b32 v52, v161, v160, s59
    v_perm_b32 v49, v163, v162, s58
    v_perm_b32 v53, v163, v162, s59
    v_perm_b32 v50, v165, v164, s58
    v_perm_b32 v54, v165, v164, s59
    v_perm_b32 v51, v167, v166, s58
    v_perm_b32 v55, v167, v166, s59
    s_waitcnt vmcnt(63)
    v_perm_b32 v56, v169, v168, s58
    v_perm_b32 v60, v169, v168, s59
    v_perm_b32 v57, v171, v170, s58
    v_perm_b32 v61, v171, v170, s59
    v_perm_b32 v58, v173, v172, s58
    v_perm_b32 v62, v173, v172, s59
    v_perm_b32 v59, v175, v174, s58
    v_perm_b32 v63, v175, v174, s59
    s_waitcnt vmcnt(56)
    v_perm_b32 v64, v177, v176, s58
    v_perm_b32 v68, v177, v176, s59
    v_perm_b32 v65, v179, v178, s58
    v_perm_b32 v69, v179, v178, s59
    v_perm_b32 v66, v181, v180, s58
    v_perm_b32 v70, v181, v180, s59
    v_perm_b32 v67, v183, v182, s58
    v_perm_b32 v71, v183, v182, s59
    s_waitcnt vmcnt(48)
    v_perm_b32 v72, v185, v184, s58
    v_perm_b32 v76, v185, v184, s59
    v_perm_b32 v73, v187, v186, s58
    v_perm_b32 v77, v187, v186, s59
    v_perm_b32 v74, v189, v188, s58
    v_perm_b32 v78, v189, v188, s59
    v_perm_b32 v75, v191, v190, s58
    v_perm_b32 v79, v191, v190, s59
    s_waitcnt vmcnt(40)
    v_perm_b32 v80, v193, v192, s58
    v_perm_b32 v84, v193, v192, s59
    v_perm_b32 v81, v195, v194, s58
    v_perm_b32 v85, v195, v194, s59
    v_perm_b32 v82, v197, v196, s58
    v_perm_b32 v86, v197, v196, s59
    v_perm_b32 v83, v199, v198, s58
    v_perm_b32 v87, v199, v198, s59
    s_waitcnt vmcnt(32)
    v_perm_b32 v88, v201, v200, s58
    v_perm_b32 v92, v201, v200, s59
    v_perm_b32 v89, v203, v202, s58
    v_perm_b32 v93, v203, v202, s59
    v_perm_b32 v90, v205, v204, s58
    v_perm_b32 v94, v205, v204, s59
    v_perm_b32 v91, v207, v206, s58
    v_perm_b32 v95, v207, v206, s59
    s_waitcnt vmcnt(24)
    v_perm_b32 v96, v209, v208, s58
    v_perm_b32 v100, v209, v208, s59
    v_perm_b32 v97, v211, v210, s58
    v_perm_b32 v101, v211, v210, s59
    v_perm_b32 v98, v213, v212, s58
    v_perm_b32 v102, v213, v212, s59
    v_perm_b32 v99, v215, v214, s58
    v_perm_b32 v103, v215, v214, s59
    s_waitcnt vmcnt(16)
    v_perm_b32 v104, v217, v216, s58
    v_perm_b32 v108, v217, v216, s59
    v_perm_b32 v105, v219, v218, s58
    v_perm_b32 v109, v219, v218, s59
    v_perm_b32 v106, v221, v220, s58
    v_perm_b32 v110, v221, v220, s59
    v_perm_b32 v107, v223, v222, s58
    v_perm_b32 v111, v223, v222, s59
    s_waitcnt vmcnt(8)
    v_perm_b32 v112, v225, v224, s58
    v_perm_b32 v116, v225, v224, s59
    v_perm_b32 v113, v227, v226, s58
    v_perm_b32 v117, v227, v226, s59
    v_perm_b32 v114, v229, v228, s58
    v_perm_b32 v118, v229, v228, s59
    v_perm_b32 v115, v231, v230, s58
    v_perm_b32 v119, v231, v230, s59
    s_waitcnt vmcnt(0)
    v_perm_b32 v120, v233, v232, s58
    v_perm_b32 v124, v233, v232, s59
    v_perm_b32 v121, v235, v234, s58
    v_perm_b32 v125, v235, v234, s59
    v_perm_b32 v122, v237, v236, s58
    v_perm_b32 v126, v237, v236, s59
    v_perm_b32 v123, v239, v238, s58
    v_perm_b32 v127, v239, v238, s59
    v_lshrrev_b32 v216, 6, v0
    v_lshlrev_b32 v216, 9, v216
    v_add_u32 v216, v216, v1
    v_sub_u32 v216, 2047, v216
    v_subrev_u32 v217, 64, v216
    v_subrev_u32 v218, 128, v216
    v_subrev_u32 v219, 192, v216
    v_subrev_u32 v220, 256, v216
    v_subrev_u32 v221, 320, v216
    v_subrev_u32 v222, 384, v216
    v_subrev_u32 v223, 448, v216
    v_lshlrev_b32 v2, 6, v0
    v_lshrrev_b32 v3, 4, v0
    v_lshlrev_b32 v3, 5, v3
    v_add_u32 v3, 8192, v3
    v_and_b32 v4, 15, v1
    v_lshlrev_b32 v4, 5, v4
    v_add_u32 v4, 8192, v4
    v_and_b32 v6, 7, v1
    v_lshlrev_b32 v6, 4, v6
    v_lshl_add_u32 v6, v13, 7, v6
    s_lshl_b32 s60, s21, 9
    v_add_u32 v6, s60, v6
    s_mov_b32 s26, 458752
    s_lshl_b32 s60, s21, 10
    v_lshlrev_b32 v7, 9, v13
    v_lshl_add_u32 v7, v12, 3, v7
    v_add_u32 v7, s60, v7
    v_lshlrev_b32 v8, 2, v0
    s_cmp_ge_u32 s22, 10
    s_cselect_b32 s60, 1, 0
    s_mul_i32 s61, s60, 10
    s_sub_u32 s61, s22, s61
    s_lshl_b32 s62, s60, 9
    s_lshl_b32 s63, s61, 1
    s_add_u32 s62, s62, s63
    s_lshl_b32 s64, s60, 7
    s_add_u32 s64, s64, s63
    s_add_u32 s64, s64, 1008
    s_cmp_lt_u32 s61, 8
    s_cselect_b32 s31, s62, s64
    s_cselect_b32 s30, 16, 4
    v_and_b32 v226, 31, v1
    v_mul_u32_u24 v9, s30, v226
    s_and_b32 s32, s31, 2
    s_lshl_b32 s32, s32, 3
    s_sub_u32 s32, 16, s32
    s_and_b32 s31, s31, -4
    v_add_u32 v9, s31, v9
    s_lshl_b32 s60, s22, 2
    s_add_u32 s60, s60, s21
    s_lshl_b32 s60, s60, 8
    v_lshl_add_u32 v10, v226, 3, s60
    v_lshrrev_b32 v227, 5, v1
    v_lshl_add_u32 v10, v227, 2, v10
    s_lshl_b32 s60, s22, 6
    v_lshl_add_u32 v11, v226, 1, s60
    s_and_b32 s23, s2, 7
    s_lshl_b32 s23, s23, 14
    s_add_u32 s23, s23, 655360
    s_mov_b32 s25, 9437184
    s_mov_b32 s28, 2688
    s_mov_b32 s27, 0
    s_cmp_lg_u32 s21, 0
    s_cbranch_scc1 Lpolld_78
    s_add_u32 s60, s29, 20480
    s_add_u32 s61, s20, 1
    v_and_b32 v225, 15, v1
    v_lshlrev_b32 v225, 6, v225
    s_mov_b32 s62, 40000
    s_nop 0
Lpoll_77:
    buffer_load_dword v224, v225, s[4:7], s60 offen sc1
    s_waitcnt vmcnt(0)
    v_cmp_ne_u32 vcc, s61, v224
    s_nop 4
    s_cbranch_vccz Lpolld_78
    s_sleep 8
    s_sub_u32 s62, s62, 1
    s_cmp_lg_u32 s62, 0
    s_cbranch_scc1 Lpoll_77
Lpolld_78:
    s_barrier
    s_setprio 3
L_FbLoop:
    s_setprio 0
    s_mov_b32 s62, 40000
    s_mov_b32 exec_lo, 0x0
    s_mov_b32 exec_hi, 0xc0000000
Lrg_80:
    buffer_load_dwordx4 v[208:211], v2, s[4:7], s23 offen sc1
    s_waitcnt vmcnt(0)
    v_max3_u32 v192, v208, v209, v210
    v_max_u32 v192, v192, v211
    v_cmp_eq_u32 vcc, -1, v192
    s_nop 4
    s_cbranch_vccz Lrgd_81
    s_sub_u32 s62, s62, 1
    s_cmp_lg_u32 s62, 0
    s_cbranch_scc1 Lrg_80
Lrgd_81:
    s_mov_b64 exec, -1
    s_mov_b32 s62, 40000
Lrg_82:
    buffer_load_dwordx4 v[208:211], v2, s[4:7], s23 offen sc1
    s_waitcnt vmcnt(0)
    v_max3_u32 v192, v208, v209, v210
    v_max_u32 v192, v192, v211
    v_cmp_eq_u32 vcc, -1, v192
    s_nop 4
    s_cbranch_vccz Lrgd_83
    s_sub_u32 s62, s62, 1
    s_cmp_lg_u32 s62, 0
    s_cbranch_scc1 Lrg_82
Lrgd_83:
    s_mov_b64 exec, -1
    s_setprio 3
Ldry_79:
    s_mov_b32 s63, 0xffff0000
    v_lshl_or_b32 v192, v208, 16, v216
    v_and_or_b32 v193, v208, s63, v217
    v_lshl_or_b32 v194, v209, 16, v218
    v_and_or_b32 v195, v209, s63, v219
    v_lshl_or_b32 v196, v210, 16, v220
    v_and_or_b32 v197, v210, s63, v221
    v_lshl_or_b32 v198, v211, 16, v222
    v_and_or_b32 v199, v211, s63, v223
    v_max_u32 v200, v192, v193
    v_min_u32 v193, v192, v193
    v_max_u32 v201, v194, v195
    v_min_u32 v195, v194, v195
    v_max_u32 v202, v196, v197
    v_min_u32 v197, v196, v197
    v_max_u32 v203, v198, v199
    v_min_u32 v199, v198, v199
    v_max_u32 v204, v200, v201
    v_min_u32 v201, v200, v201
    v_max_u32 v205, v193, v195
    v_min_u32 v195, v193, v195
    v_max_u32 v206, v202, v203
    v_min_u32 v203, v202, v203
    v_max_u32 v207, v197, v199
    v_min_u32 v199, v197, v199
    v_max_u32 v208, v205, v201
    v_min_u32 v201, v205, v201
    v_max_u32 v209, v207, v203
    v_min_u32 v203, v207, v203
    v_max_u32 v210, v204, v206
    v_min_u32 v206, v204, v206
    v_max_u32 v211, v195, v199
    v_min_u32 v199, v195, v199
    v_max_u32 v212, v208, v209
    v_min_u32 v209, v208, v209
    v_max_u32 v213, v201, v203
    v_min_u32 v203, v201, v203
    v_max_u32 v214, v212, v206
    v_min_u32 v206, v212, v206
    v_max_u32 v215, v211, v203
    v_min_u32 v203, v211, v203
    v_max_u32 v192, v213, v206
    v_min_u32 v206, v213, v206
    v_max_u32 v194, v215, v209
    v_min_u32 v209, v215, v209
    v_max_u32 v196, v194, v206
    v_min_u32 v206, v194, v206
    v_max_u32_dpp v198, v199, v210 quad_perm:[1,0,3,2] row_mask:0xf bank_mask:0xf
    v_max_u32_dpp v200, v203, v214 quad_perm:[1,0,3,2] row_mask:0xf bank_mask:0xf
    v_max_u32_dpp v193, v209, v192 quad_perm:[1,0,3,2] row_mask:0xf bank_mask:0xf
    v_max_u32_dpp v202, v206, v196 quad_perm:[1,0,3,2] row_mask:0xf bank_mask:0xf
    v_max_u32_dpp v197, v196, v206 quad_perm:[1,0,3,2] row_mask:0xf bank_mask:0xf
    v_max_u32_dpp v205, v192, v209 quad_perm:[1,0,3,2] row_mask:0xf bank_mask:0xf
    v_max_u32_dpp v207, v214, v203 quad_perm:[1,0,3,2] row_mask:0xf bank_mask:0xf
    v_max_u32_dpp v204, v210, v199 quad_perm:[1,0,3,2] row_mask:0xf bank_mask:0xf
    v_max_u32 v195, v198, v197
    v_min_u32 v197, v198, v197
    v_max_u32 v208, v200, v205
    v_min_u32 v205, v200, v205
    v_max_u32 v201, v193, v207
    v_min_u32 v207, v193, v207
    v_max_u32 v212, v202, v204
    v_min_u32 v204, v202, v204
    v_max_u32 v211, v195, v201
    v_min_u32 v201, v195, v201
    v_max_u32 v213, v208, v212
    v_min_u32 v212, v208, v212
    v_max_u32 v215, v197, v207
    v_min_u32 v207, v197, v207
    v_max_u32 v194, v205, v204
    v_min_u32 v204, v205, v204
    v_max_u32 v210, v207, v204
    v_min_u32 v204, v207, v204
    v_max_u32 v214, v215, v194
    v_min_u32 v194, v215, v194
    v_max_u32 v192, v201, v212
    v_min_u32 v212, v201, v212
    v_max_u32 v196, v211, v213
    v_min_u32 v213, v211, v213
    s_nop 0
    v_max_u32_dpp v206, v204, v196 quad_perm:[2,3,0,1] row_mask:0xf bank_mask:0xf
    v_max_u32_dpp v209, v210, v213 quad_perm:[2,3,0,1] row_mask:0xf bank_mask:0xf
    v_max_u32_dpp v203, v194, v192 quad_perm:[2,3,0,1] row_mask:0xf bank_mask:0xf
    v_max_u32_dpp v199, v214, v212 quad_perm:[2,3,0,1] row_mask:0xf bank_mask:0xf
    v_max_u32_dpp v198, v212, v214 quad_perm:[2,3,0,1] row_mask:0xf bank_mask:0xf
    v_max_u32_dpp v200, v192, v194 quad_perm:[2,3,0,1] row_mask:0xf bank_mask:0xf
    v_max_u32_dpp v193, v213, v210 quad_perm:[2,3,0,1] row_mask:0xf bank_mask:0xf
    v_max_u32_dpp v202, v196, v204 quad_perm:[2,3,0,1] row_mask:0xf bank_mask:0xf
    v_max_u32 v195, v206, v198
    v_min_u32 v198, v206, v198
    v_max_u32 v208, v209, v200
    v_min_u32 v200, v209, v200
    v_max_u32 v197, v203, v193
    v_min_u32 v193, v203, v193
    v_max_u32 v205, v199, v202
    v_min_u32 v202, v199, v202
    v_max_u32 v207, v195, v197
    v_min_u32 v197, v195, v197
    v_max_u32 v215, v208, v205
    v_min_u32 v205, v208, v205
    v_max_u32 v201, v198, v193
    v_min_u32 v193, v198, v193
    v_max_u32 v211, v200, v202
    v_min_u32 v202, v200, v202
    v_max_u32 v196, v193, v202
    v_min_u32 v202, v193, v202
    v_max_u32 v213, v201, v211
    v_min_u32 v211, v201, v211
    v_max_u32 v192, v197, v205
    v_min_u32 v205, v197, v205
    v_max_u32 v212, v207, v215
    v_min_u32 v215, v207, v215
    s_nop 0
    v_max_u32_dpp v214, v202, v212 row_half_mirror row_mask:0xf bank_mask:0xf
    v_max_u32_dpp v194, v196, v215 row_half_mirror row_mask:0xf bank_mask:0xf
    v_max_u32_dpp v210, v211, v192 row_half_mirror row_mask:0xf bank_mask:0xf
    v_max_u32_dpp v204, v213, v205 row_half_mirror row_mask:0xf bank_mask:0xf
    v_max_u32_dpp v206, v205, v213 row_half_mirror row_mask:0xf bank_mask:0xf
    v_max_u32_dpp v209, v192, v211 row_half_mirror row_mask:0xf bank_mask:0xf
    v_max_u32_dpp v203, v215, v196 row_half_mirror row_mask:0xf bank_mask:0xf
    v_max_u32_dpp v199, v212, v202 row_half_mirror row_mask:0xf bank_mask:0xf
    v_max_u32 v195, v214, v206
    v_min_u32 v206, v214, v206
    v_max_u32 v208, v194, v209
    v_min_u32 v209, v194, v209
    v_max_u32 v198, v210, v203
    v_min_u32 v203, v210, v203
    v_max_u32 v200, v204, v199
    v_min_u32 v199, v204, v199
    v_max_u32 v193, v195, v198
    v_min_u32 v198, v195, v198
    v_max_u32 v201, v208, v200
    v_min_u32 v200, v208, v200
    v_max_u32 v197, v206, v203
    v_min_u32 v203, v206, v203
    v_max_u32 v207, v209, v199
    v_min_u32 v199, v209, v199
    v_max_u32 v212, v203, v199
    v_min_u32 v199, v203, v199
    v_max_u32 v215, v197, v207
    v_min_u32 v207, v197, v207
    v_max_u32 v192, v198, v200
    v_min_u32 v200, v198, v200
    v_max_u32 v205, v193, v201
    v_min_u32 v201, v193, v201
    s_nop 0
    v_max_u32_dpp v213, v199, v205 row_mirror row_mask:0xf bank_mask:0xf
    v_max_u32_dpp v211, v212, v201 row_mirror row_mask:0xf bank_mask:0xf
    v_max_u32_dpp v196, v207, v192 row_mirror row_mask:0xf bank_mask:0xf
    v_max_u32_dpp v202, v215, v200 row_mirror row_mask:0xf bank_mask:0xf
    v_max_u32_dpp v214, v200, v215 row_mirror row_mask:0xf bank_mask:0xf
    v_max_u32_dpp v194, v192, v207 row_mirror row_mask:0xf bank_mask:0xf
    v_max_u32_dpp v210, v201, v212 row_mirror row_mask:0xf bank_mask:0xf
    v_max_u32_dpp v204, v205, v199 row_mirror row_mask:0xf bank_mask:0xf
    v_max_u32 v195, v213, v214
    v_min_u32 v214, v213, v214
    v_max_u32 v208, v211, v194
    v_min_u32 v194, v211, v194
    v_max_u32 v206, v196, v210
    v_min_u32 v210, v196, v210
    v_max_u32 v209, v202, v204
    v_min_u32 v204, v202, v204
    v_max_u32 v203, v195, v206
    v_min_u32 v206, v195, v206
    v_max_u32 v197, v208, v209
    v_min_u32 v209, v208, v209
    v_max_u32 v198, v214, v210
    v_min_u32 v210, v214, v210
    v_max_u32 v193, v194, v204
    v_min_u32 v204, v194, v204
    v_max_u32 v224, v203, v197
    v_min_u32 v225, v203, v197
    v_max_u32 v226, v206, v209
    v_min_u32 v227, v206, v209
    v_max_u32 v228, v198, v193
    v_min_u32 v229, v198, v193
    v_max_u32 v230, v210, v204
    v_min_u32 v231, v210, v204
    s_mov_b32 exec_lo, 0x10001
    s_mov_b32 exec_hi, 0x10001
    ds_write_b128 v3, v[224:227]
    ds_write_b128 v3, v[228:231] offset:16
    s_mov_b64 exec, -1
    s_waitcnt lgkmcnt(0)
    s_barrier
    ds_read_b128 v[192:195], v4
    ds_read_b128 v[196:199], v4 offset:16
    s_waitcnt lgkmcnt(0)
    v_max_u32_dpp v200, v199, v192 quad_perm:[1,0,3,2] row_mask:0xf bank_mask:0xf
    v_max_u32_dpp v201, v198, v193 quad_perm:[1,0,3,2] row_mask:0xf bank_mask:0xf
    v_max_u32_dpp v202, v197, v194 quad_perm:[1,0,3,2] row_mask:0xf bank_mask:0xf
    v_max_u32_dpp v203, v196, v195 quad_perm:[1,0,3,2] row_mask:0xf bank_mask:0xf
    v_max_u32_dpp v204, v195, v196 quad_perm:[1,0,3,2] row_mask:0xf bank_mask:0xf
    v_max_u32_dpp v205, v194, v197 quad_perm:[1,0,3,2] row_mask:0xf bank_mask:0xf
    v_max_u32_dpp v206, v193, v198 quad_perm:[1,0,3,2] row_mask:0xf bank_mask:0xf
    v_max_u32_dpp v207, v192, v199 quad_perm:[1,0,3,2] row_mask:0xf bank_mask:0xf
    v_max_u32 v208, v200, v204
    v_min_u32 v204, v200, v204
    v_max_u32 v209, v201, v205
    v_min_u32 v205, v201, v205
    v_max_u32 v210, v202, v206
    v_min_u32 v206, v202, v206
    v_max_u32 v211, v203, v207
    v_min_u32 v207, v203, v207
    v_max_u32 v212, v208, v210
    v_min_u32 v210, v208, v210
    v_max_u32 v213, v209, v211
    v_min_u32 v211, v209, v211
    v_max_u32 v214, v204, v206
    v_min_u32 v206, v204, v206
    v_max_u32 v215, v205, v207
    v_min_u32 v207, v205, v207
    v_max_u32 v192, v206, v207
    v_min_u32 v207, v206, v207
    v_max_u32 v193, v214, v215
    v_min_u32 v215, v214, v215
    v_max_u32 v194, v210, v211
    v_min_u32 v211, v210, v211
    v_max_u32 v195, v212, v213
    v_min_u32 v213, v212, v213
    s_nop 0
    v_max_u32_dpp v196, v207, v195 quad_perm:[2,3,0,1] row_mask:0xf bank_mask:0xf
    v_max_u32_dpp v197, v192, v213 quad_perm:[2,3,0,1] row_mask:0xf bank_mask:0xf
    v_max_u32_dpp v198, v215, v194 quad_perm:[2,3,0,1] row_mask:0xf bank_mask:0xf
    v_max_u32_dpp v199, v193, v211 quad_perm:[2,3,0,1] row_mask:0xf bank_mask:0xf
    v_max_u32_dpp v200, v211, v193 quad_perm:[2,3,0,1] row_mask:0xf bank_mask:0xf
    v_max_u32_dpp v201, v194, v215 quad_perm:[2,3,0,1] row_mask:0xf bank_mask:0xf
    v_max_u32_dpp v202, v213, v192 quad_perm:[2,3,0,1] row_mask:0xf bank_mask:0xf
    v_max_u32_dpp v203, v195, v207 quad_perm:[2,3,0,1] row_mask:0xf bank_mask:0xf
    v_max_u32 v208, v196, v200
    v_min_u32 v200, v196, v200
    v_max_u32 v209, v197, v201
    v_min_u32 v201, v197, v201
    v_max_u32 v204, v198, v202
    v_min_u32 v202, v198, v202
    v_max_u32 v205, v199, v203
    v_min_u32 v203, v199, v203
    v_max_u32 v206, v208, v204
    v_min_u32 v204, v208, v204
    v_max_u32 v214, v209, v205
    v_min_u32 v205, v209, v205
    v_max_u32 v210, v200, v202
    v_min_u32 v202, v200, v202
    v_max_u32 v212, v201, v203
    v_min_u32 v203, v201, v203
    v_max_u32 v195, v202, v203
    v_min_u32 v203, v202, v203
    v_max_u32 v213, v210, v212
    v_min_u32 v212, v210, v212
    v_max_u32 v194, v204, v205
    v_min_u32 v205, v204, v205
    v_max_u32 v211, v206, v214
    v_min_u32 v214, v206, v214
    s_nop 0
    v_max_u32_dpp v193, v203, v211 row_half_mirror row_mask:0xf bank_mask:0xf
    v_max_u32_dpp v215, v195, v214 row_half_mirror row_mask:0xf bank_mask:0xf
    v_max_u32_dpp v192, v212, v194 row_half_mirror row_mask:0xf bank_mask:0xf
    v_max_u32_dpp v207, v213, v205 row_half_mirror row_mask:0xf bank_mask:0xf
    v_max_u32_dpp v196, v205, v213 row_half_mirror row_mask:0xf bank_mask:0xf
    v_max_u32_dpp v197, v194, v212 row_half_mirror row_mask:0xf bank_mask:0xf
    v_max_u32_dpp v198, v214, v195 row_half_mirror row_mask:0xf bank_mask:0xf
    v_max_u32_dpp v199, v211, v203 row_half_mirror row_mask:0xf bank_mask:0xf
    v_max_u32 v208, v193, v196
    v_min_u32 v196, v193, v196
    v_max_u32 v209, v215, v197
    v_min_u32 v197, v215, v197
    v_max_u32 v200, v192, v198
    v_min_u32 v198, v192, v198
    v_max_u32 v201, v207, v199
    v_min_u32 v199, v207, v199
    v_max_u32 v202, v208, v200
    v_min_u32 v200, v208, v200
    v_max_u32 v210, v209, v201
    v_min_u32 v201, v209, v201
    v_max_u32 v204, v196, v198
    v_min_u32 v198, v196, v198
    v_max_u32 v206, v197, v199
    v_min_u32 v199, v197, v199
    v_max_u32 v211, v198, v199
    v_min_u32 v199, v198, v199
    v_max_u32 v214, v204, v206
    v_min_u32 v206, v204, v206
    v_max_u32 v194, v200, v201
    v_min_u32 v201, v200, v201
    v_max_u32 v205, v202, v210
    v_min_u32 v210, v202, v210
    s_nop 0
    v_max_u32_dpp v213, v199, v205 row_mirror row_mask:0xf bank_mask:0xf
    v_max_u32_dpp v212, v211, v210 row_mirror row_mask:0xf bank_mask:0xf
    v_max_u32_dpp v195, v206, v194 row_mirror row_mask:0xf bank_mask:0xf
    v_max_u32_dpp v203, v214, v201 row_mirror row_mask:0xf bank_mask:0xf
    v_max_u32_dpp v193, v201, v214 row_mirror row_mask:0xf bank_mask:0xf
    v_max_u32_dpp v215, v194, v206 row_mirror row_mask:0xf bank_mask:0xf
    v_max_u32_dpp v192, v210, v211 row_mirror row_mask:0xf bank_mask:0xf
    v_max_u32_dpp v207, v205, v199 row_mirror row_mask:0xf bank_mask:0xf
    v_readfirstlane_b32 s80, v213
    v_readfirstlane_b32 s81, v212
    v_readfirstlane_b32 s82, v195
    v_readfirstlane_b32 s83, v203
    v_readfirstlane_b32 s84, v193
    v_readfirstlane_b32 s85, v215
    v_readfirstlane_b32 s86, v192
    v_readfirstlane_b32 s87, v207
    s_mov_b32 s70, s80
    s_mov_b32 s71, s81
    s_cmp_eq_u32 s21, 1
    s_cselect_b32 s70, s82, s70
    s_cselect_b32 s71, s83, s71
    s_cmp_eq_u32 s21, 2
    s_cselect_b32 s70, s84, s70
    s_cselect_b32 s71, s85, s71
    s_cmp_eq_u32 s21, 3
    s_cselect_b32 s70, s86, s70
    s_cselect_b32 s71, s87, s71
    s_or_b32 s60, s22, s21
    s_cmp_lg_u32 s60, 0
    s_cbranch_scc1 Lfb_84
    v_mov_b32 v230, s80
    v_writelane_b32 v230, s81, 1
    v_writelane_b32 v230, s82, 2
    v_writelane_b32 v230, s83, 3
    v_writelane_b32 v230, s84, 4
    v_writelane_b32 v230, s85, 5
    v_writelane_b32 v230, s86, 6
    v_writelane_b32 v230, s87, 7
    v_and_b32 v230, 0x7ff, v230
    v_sub_u32 v230, 2047, v230
    v_lshlrev_b32 v231, 2, v1
    s_lshl_b32 s60, s27, 8
    s_add_u32 s60, s60, 610304
    s_mov_b64 exec, 0xff
    buffer_store_dword v230, v231, s[4:7], s60 offen sc1
    s_mov_b64 exec, -1
Lfb_84:
    v_mov_b32 v224, s71
    v_mov_b32 v225, s70
    v_cmp_gt_u32 vcc, 32, v1
    s_nop 1
    v_cndmask_b32 v224, v224, v225, vcc
    v_and_b32 v225, 0x7ff, v224
    v_sub_u32 v225, 2047, v225
    v_mad_u32_u24 v229, v225, s28, v9
    s_setprio 0
    v_mul_u32_u24 v230, s28, v225
    s_add_u32 s61, s20, 6
    s_add_u32 s61, s61, s27
    s_mov_b32 s62, 40000
Lst2_85:
    buffer_load_dwordx4 v[232:235], v230, s[4:7], s25 offen offset:2560 sc1
    s_waitcnt vmcnt(0)
    v_cmp_ne_u32 vcc, s61, v234
    s_nop 4
    s_cbranch_vccz Lst2d_86
    s_sleep 2
    s_sub_u32 s62, s62, 1
    s_cmp_lg_u32 s62, 0
    s_cbranch_scc1 Lst2_85
Lst2d_86:
    buffer_load_dword v227, v229, s[4:7], s25 offen sc1
    buffer_load_dword v226, v229, s[4:7], s25 offen offset:1280 sc1
    v_ashrrev_i32 v228, 31, v224
    v_not_b32 v228, v228
    v_or_b32 v228, 0x80000000, v228
    v_xor_b32 v228, v228, v224
    v_and_b32 v228, 0xffff0000, v228
    v_mul_f32 v228, 0xbfb8aa3b, v228
    v_exp_f32 v228, v228
    s_nop 0
    v_add_f32 v228, 1.0, v228
    v_rcp_f32 v228, v228
    s_nop 0
    v_cvt_pk_bf16_f32 v228, v228, v228
    v_and_b32 v228, 0xffff0000, v228
    s_mov_b32 s62, 40000
    s_mov_b32 exec_lo, 0xff00ff
    s_mov_b32 exec_hi, 0xff00ff
Lh_87:
    buffer_load_dwordx4 v[128:131], v6, s[4:7], s26 offen sc1
    s_waitcnt vmcnt(0)
    v_max3_u32 v230, v128, v129, v130
    v_max_u32 v230, v230, v131
    v_cmp_eq_u32 vcc, -1, v230
    s_nop 4
    s_cbranch_vccz Lhd_88
    s_sleep 1
    s_sub_u32 s62, s62, 1
    s_cmp_lg_u32 s62, 0
    s_cbranch_scc1 Lh_87
Lhd_88:
    s_cmp_lt_u32 s21, 2
    s_cselect_b32 s63, 2048, 0
    s_add_u32 s63, s63, 24576
    s_add_u32 s63, s63, s26
    s_mov_b32 s62, 40000
    s_mov_b32 exec_lo, 0xff00ff
    s_mov_b32 exec_hi, 0xff00ff
Lh_89:
    s_add_u32 s60, s26, 0
    buffer_load_dwordx4 v[128:131], v6, s[4:7], s60 offen offset:0 sc1
    buffer_load_dwordx4 v[132:135], v6, s[4:7], s60 offen offset:2048 sc1
    s_add_u32 s60, s26, 4096
    buffer_load_dwordx4 v[136:139], v6, s[4:7], s60 offen offset:0 sc1
    buffer_load_dwordx4 v[140:143], v6, s[4:7], s60 offen offset:2048 sc1
    s_add_u32 s60, s26, 8192
    buffer_load_dwordx4 v[144:147], v6, s[4:7], s60 offen offset:0 sc1
    buffer_load_dwordx4 v[148:151], v6, s[4:7], s60 offen offset:2048 sc1
    s_add_u32 s60, s26, 12288
    buffer_load_dwordx4 v[152:155], v6, s[4:7], s60 offen offset:0 sc1
    buffer_load_dwordx4 v[156:159], v6, s[4:7], s60 offen offset:2048 sc1
    s_add_u32 s60, s26, 16384
    buffer_load_dwordx4 v[160:163], v6, s[4:7], s60 offen offset:0 sc1
    buffer_load_dwordx4 v[164:167], v6, s[4:7], s60 offen offset:2048 sc1
    s_add_u32 s60, s26, 20480
    buffer_load_dwordx4 v[168:171], v6, s[4:7], s60 offen offset:0 sc1
    buffer_load_dwordx4 v[172:175], v6, s[4:7], s60 offen offset:2048 sc1
    s_add_u32 s60, s26, 24576
    buffer_load_dwordx4 v[176:179], v6, s[4:7], s60 offen offset:0 sc1
    buffer_load_dwordx4 v[180:183], v6, s[4:7], s63 offen sc1
    s_mov_b64 exec, -1
    s_waitcnt vmcnt(13)
    v_mfma_f32_16x16x32_bf16 v[184:187], v[128:131], v[16:19], 0
    v_mfma_f32_16x16x32_bf16 v[188:191], v[128:131], v[20:23], 0
    v_max3_u32 v230, v128, v129, v130
    v_max_u32 v230, v230, v131
    s_waitcnt vmcnt(12)
    v_mfma_f32_16x16x32_bf16 v[184:187], v[132:135], v[24:27], v[184:187]
    v_mfma_f32_16x16x32_bf16 v[188:191], v[132:135], v[28:31], v[188:191]
    v_max3_u32 v230, v230, v132, v133
    v_max3_u32 v230, v230, v134, v135
    s_waitcnt vmcnt(11)
    v_mfma_f32_16x16x32_bf16 v[184:187], v[136:139], v[32:35], v[184:187]
    v_mfma_f32_16x16x32_bf16 v[188:191], v[136:139], v[36:39], v[188:191]
    v_max3_u32 v230, v230, v136, v137
    v_max3_u32 v230, v230, v138, v139
    s_waitcnt vmcnt(10)
    v_mfma_f32_16x16x32_bf16 v[184:187], v[140:143], v[40:43], v[184:187]
    v_mfma_f32_16x16x32_bf16 v[188:191], v[140:143], v[44:47], v[188:191]
    v_max3_u32 v230, v230, v140, v141
    v_max3_u32 v230, v230, v142, v143
    s_waitcnt vmcnt(9)
    v_mfma_f32_16x16x32_bf16 v[184:187], v[144:147], v[48:51], v[184:187]
    v_mfma_f32_16x16x32_bf16 v[188:191], v[144:147], v[52:55], v[188:191]
    v_max3_u32 v230, v230, v144, v145
    v_max3_u32 v230, v230, v146, v147
    s_waitcnt vmcnt(8)
    v_mfma_f32_16x16x32_bf16 v[184:187], v[148:151], v[56:59], v[184:187]
    v_mfma_f32_16x16x32_bf16 v[188:191], v[148:151], v[60:63], v[188:191]
    v_max3_u32 v230, v230, v148, v149
    v_max3_u32 v230, v230, v150, v151
    s_waitcnt vmcnt(7)
    v_mfma_f32_16x16x32_bf16 v[184:187], v[152:155], v[64:67], v[184:187]
    v_mfma_f32_16x16x32_bf16 v[188:191], v[152:155], v[68:71], v[188:191]
    v_max3_u32 v230, v230, v152, v153
    v_max3_u32 v230, v230, v154, v155
    s_waitcnt vmcnt(6)
    v_mfma_f32_16x16x32_bf16 v[184:187], v[156:159], v[72:75], v[184:187]
    v_mfma_f32_16x16x32_bf16 v[188:191], v[156:159], v[76:79], v[188:191]
    v_max3_u32 v230, v230, v156, v157
    v_max3_u32 v230, v230, v158, v159
    s_waitcnt vmcnt(5)
    v_mfma_f32_16x16x32_bf16 v[184:187], v[160:163], v[80:83], v[184:187]
    v_mfma_f32_16x16x32_bf16 v[188:191], v[160:163], v[84:87], v[188:191]
    v_max3_u32 v230, v230, v160, v161
    v_max3_u32 v230, v230, v162, v163
    s_waitcnt vmcnt(4)
    v_mfma_f32_16x16x32_bf16 v[184:187], v[164:167], v[88:91], v[184:187]
    v_mfma_f32_16x16x32_bf16 v[188:191], v[164:167], v[92:95], v[188:191]
    v_max3_u32 v230, v230, v164, v165
    v_max3_u32 v230, v230, v166, v167
    s_waitcnt vmcnt(3)
    v_mfma_f32_16x16x32_bf16 v[184:187], v[168:171], v[96:99], v[184:187]
    v_mfma_f32_16x16x32_bf16 v[188:191], v[168:171], v[100:103], v[188:191]
    v_max3_u32 v230, v230, v168, v169
    v_max3_u32 v230, v230, v170, v171
    s_waitcnt vmcnt(2)
    v_mfma_f32_16x16x32_bf16 v[184:187], v[172:175], v[104:107], v[184:187]
    v_mfma_f32_16x16x32_bf16 v[188:191], v[172:175], v[108:111], v[188:191]
    v_max3_u32 v230, v230, v172, v173
    v_max3_u32 v230, v230, v174, v175
    s_waitcnt vmcnt(1)
    v_mfma_f32_16x16x32_bf16 v[184:187], v[176:179], v[112:115], v[184:187]
    v_mfma_f32_16x16x32_bf16 v[188:191], v[176:179], v[116:119], v[188:191]
    v_max3_u32 v230, v230, v176, v177
    v_max3_u32 v230, v230, v178, v179
    s_waitcnt vmcnt(0)
    v_mfma_f32_16x16x32_bf16 v[184:187], v[180:183], v[120:123], v[184:187]
    v_mfma_f32_16x16x32_bf16 v[188:191], v[180:183], v[124:127], v[188:191]
    v_max3_u32 v230, v230, v180, v181
    v_max3_u32 v230, v230, v182, v183
    s_mov_b32 exec_lo, 0xff00ff
    s_mov_b32 exec_hi, 0xff00ff
    v_cmp_eq_u32 vcc, -1, v230
    s_nop 4
    s_cbranch_vccz Lhd_90
    s_sleep 1
    s_sub_u32 s62, s62, 1
    s_cmp_lg_u32 s62, 0
    s_cbranch_scc1 Lh_89
Lhd_90:
    s_mov_b64 exec, -1
    s_setprio 3
    s_or_b32 s60, s22, s21
    s_or_b32 s60, s60, s27
    s_cmp_lg_u32 s60, 0
    s_cbranch_scc1 Lfb_91
    v_mov_b32 v230, 0
    s_mov_b32 s60, 610432
    s_mov_b64 exec, 1
    buffer_store_dword v230, v230, s[4:7], s60 offen sc1
Lfb_91:
    s_mov_b64 exec, -1
    v_lshlrev_b32 v227, s32, v227
    v_and_b32 v227, 0xffff0000, v227
    v_lshlrev_b32 v226, s32, v226
    v_and_b32 v226, 0xffff0000, v226
    v_add_f32 v240, v226, v227
    v_cvt_pk_bf16_f32 v240, v240, v240
    v_and_b32 v240, 0xffff0000, v240
    v_mul_f32 v232, v232, v233
    v_fma_f32 v240, v240, v233, -v232
    s_mov_b32 exec_lo, 0xffffffff
    s_mov_b32 exec_hi, 0x0
    ds_write2_b32 v7, v184, v188 offset0:0 offset1:1
    ds_write2_b32 v7, v185, v189 offset0:32 offset1:33
    ds_write2_b32 v7, v186, v190 offset0:64 offset1:65
    ds_write2_b32 v7, v187, v191 offset0:96 offset1:97
    s_mov_b64 exec, -1
    s_waitcnt lgkmcnt(0)
    s_barrier
    ds_read2st64_b32 v[236:237], v8 offset0:0 offset1:4
    ds_read2st64_b32 v[238:239], v8 offset0:8 offset1:12
    s_waitcnt lgkmcnt(0)
    v_pk_add_f32 v[236:237], v[236:237], v[238:239]
    v_add_f32 v236, v236, v237
    v_cvt_pk_bf16_f32 v236, v236, v236
    v_and_b32 v236, 0xffff0000, v236
    v_mul_f32 v236, v236, v228
    v_cvt_pk_bf16_f32 v236, v236, v236
    v_and_b32 v236, 0xffff0000, v236
    v_add_f32 v236, v236, v227
    v_cvt_pk_bf16_f32 v236, v236, v236
    v_and_b32 v236, 0xffff0000, v236
    v_add_f32 v236, v236, v226
    s_cmp_lg_u32 s27, 0
    s_nop 0
    s_cbranch_scc1 Lfb_92
    v_permlane32_swap_b32 v236, v240
    v_cvt_pk_bf16_f32 v237, v236, v240
    v_cvt_pk_f16_f32 v236, v236, v240
    v_cmp_gt_u32 vcc, 32, v1
    s_nop 1
    v_cndmask_b32 v236, v236, v237, vcc
    v_min_u32 v236, -2, v236
    s_mov_b32 s60, 589824
    buffer_store_dword v236, v10, s[4:7], s60 offen sc1
    s_add_u32 s26, s26, 57344
    s_add_u32 s23, s23, 131072
    s_add_u32 s25, s25, 5505024
    s_mov_b32 s27, 1
    s_branch L_FbLoop
Lfb_92:
    v_cvt_pk_bf16_f32 v236, v236, v236
    s_movk_i32 s60, 1280
    v_mad_u32_u24 v237, v225, s60, v11
    buffer_store_short v236, v237, s[12:15], 0 offen sc1
    s_or_b32 s60, s22, s21
    s_cmp_lg_u32 s60, 0
    s_cbranch_scc1 L_end
    v_mov_b32 v224, s20
    v_mov_b32 v225, 0
    s_mov_b64 exec, 1
    buffer_store_dword v224, v225, s[4:7], 0 offen sc1
L_end:
    s_endpgm
L_code_end:
.section .rodata,"a"
.p2align 6
.amdhsa_kernel interleave_layers__spectral_fnet__moe_arch_mod__prompt_kernel
  .amdhsa_next_free_vgpr 256
  .amdhsa_next_free_sgpr 102
  .amdhsa_accum_offset 256
  .amdhsa_group_segment_fixed_size 0
  .amdhsa_kernarg_size 104
  .amdhsa_user_sgpr_count 2
  .amdhsa_user_sgpr_kernarg_segment_ptr 1
  .amdhsa_system_sgpr_workgroup_id_x 1
  .amdhsa_float_denorm_mode_32 3
.end_amdhsa_kernel
```
